```python
import torch

def _softmax(x, axis=-1):
    return torch.softmax(x, dim=axis)

def _gelu(x):
    return torch.nn.functional.gelu(x, approximate='tanh')

def _silu(x):
    return torch.nn.functional.silu(x)

def _sigmoid(x):
    return torch.sigmoid(x)

def _layernorm(x, axis=-1, eps=1e-05):
    m = x.mean(dim=axis, keepdim=True)
    v = x.var(dim=axis, keepdim=True, unbiased=False)
    return (x - m) / torch.sqrt(v + eps)

def _scatter_add(tgt, idx, src, axis=0):
    return tgt.clone().index_add_(axis, idx, src)

def _segment_sum(src, seg, n):
    out = torch.zeros((n,) + src.shape[1:], dtype=src.dtype)
    return out.index_add_(0, seg, src)

def _pad(x, pw):
    flat = tuple((v for pair in reversed(pw) for v in pair))
    return torch.nn.functional.pad(x, flat)
kernel_name = 'adaLN_cond__sliding_block__dense_activation_relu__prompt'

def setup_inputs():

    _w = lambda a: (lambda t: t.to(torch.bfloat16) if t.is_floating_point() else t)(torch.as_tensor(a))

    def _A_setup():
        B, S, D = (1, 2048, 512)
        return {'x': _w((lambda *s: torch.randn(*s, dtype=torch.bfloat16) * 0.05)(B, S, D)), 'wqkv': _w((lambda *s: torch.randn(*s, dtype=torch.bfloat16) * 0.05)(D, 3 * D)), 'wo': _w((lambda *s: torch.randn(*s, dtype=torch.bfloat16) * 0.05)(D, D))}
    _A_in = _A_setup()

    def _B_setup():
        B, S, D, Dff = (1, 2048, 512, 1792)
        return {'x': _w((lambda *s: torch.randn(*s, dtype=torch.bfloat16) * 0.05)(B, S, D)), 'w1': _w((lambda *s: torch.randn(*s, dtype=torch.bfloat16) * 0.05)(D, Dff)), 'w2': _w((lambda *s: torch.randn(*s, dtype=torch.bfloat16) * 0.05)(Dff, D))}
    _B_in = _B_setup()
    return {'A_x': _A_in['x'], 'A_wqkv': _A_in['wqkv'], 'A_wo': _A_in['wo'], 'B_x': _B_in['x'], 'B_w1': _B_in['w1'], 'B_w2': _B_in['w2'], 'c': _w((lambda *s: torch.randn(*s, dtype=torch.bfloat16) * 0.1)(1, 512) * 8.0), 'w_mod': _w((lambda *s: torch.randn(*s, dtype=torch.bfloat16) * 0.1)(512, 6 * 512) * 512 ** (-0.5) * 8.0)}

def reference(A_x, A_wqkv, A_wo, B_x, B_w1, B_w2, c, w_mod):

    def _A_ref(x, wqkv, wo):
        B, S, D = x.shape
        H = 32
        Dh = D // H
        W = 256
        qkv = (lambda x, *d: x.permute(*d))((x @ wqkv).reshape(B, S, 3, H, Dh), 2, 0, 3, 1, 4)
        q, k, v = (qkv[0], qkv[1], qkv[2])
        scores = torch.einsum('bhqd,bhkd->bhqk', q, k) * Dh ** (-0.5)
        idx = torch.arange(S)
        mask = (idx[:, None] - idx[None, :] >= 0) & (idx[:, None] - idx[None, :] < W)
        scores = torch.where(mask[None, None], scores, -1000000000.0)
        p = _softmax(scores, axis=-1)
        o = torch.einsum('bhqk,bhkd->bhqd', p, v)
        return (lambda x, *d: x.permute(*d))(o, 0, 2, 1, 3).reshape(B, S, D) @ wo

    def _B_ref(x, w1, w2):
        h = torch.einsum('bsd,df->bsf', x, w1)
        zero = torch.zeros_like(h)
        h = torch.maximum(h, zero)
        return torch.einsum('bsf,fd->bsd', h, w2)
    x = A_x
    mod = (_silu(c) @ w_mod).reshape(c.shape[0], 6, 1, -1)
    sa, ca, ga, sb, cb, gb = (mod[:, 0].clone(), mod[:, 1].clone(), mod[:, 2].clone(), mod[:, 3].clone(), mod[:, 4].clone(), mod[:, 5].clone())
    h = _layernorm(x, axis=-1) * (1 + ca) + sa
    x = x + ga * _A_ref(h, A_wqkv, A_wo)
    h = _layernorm(x, axis=-1) * (1 + cb) + sb
    x = x + gb * _B_ref(h, B_w1, B_w2)
    return x
```

```asm
; @launch grid=(256,1,1) block=(256,1,1) lds=163840
.amdgcn_target "amdgcn-amd-amdhsa--gfx950"
.text
.globl adaLN_cond__sliding_block__dense_activation_relu__prompt_kernel
.p2align 8
.type adaLN_cond__sliding_block__dense_activation_relu__prompt_kernel,@function
adaLN_cond__sliding_block__dense_activation_relu__prompt_kernel:
  s_cmp_ge_u32 s2, 256
  s_cbranch_scc1 L_end
  s_load_dwordx16 s[4:19], s[0:1], 0
  s_load_dwordx2 s[20:21], s[0:1], 64
  s_load_dwordx2 s[24:25], s[0:1], 80
  v_and_b32 v1, 63, v0
  v_lshrrev_b32 v3, 6, v0
  v_lshlrev_b32 v2, 4, v1
  v_readfirstlane_b32 s60, v3
  s_and_b32 s26, s2, 7
  s_lshr_b32 s27, s2, 3
  s_and_b32 s62, s27, 7
  s_and_b32 s63, s27, 15
  s_lshr_b32 s27, s27, 3
  s_lshl_b32 s26, s26, 2
  s_add_u32 s61, s26, s27
  s_lshr_b32 s64, s61, 1
  v_lshlrev_b32 v253, 6, v1
  s_cmp_lg_u32 s60, 3
  s_cbranch_scc1 L_cpf_1
  s_cmp_ge_u32 s2, 144
  s_cbranch_scc1 L_cpf_1
  s_getpc_b64 s[70:71]
  s_lshr_b32 s69, s2, 3
  s_lshl_b32 s69, s69, 11
  s_andn2_b32 s70, s70, 0xfff
  v_add_u32 v3, s69, v253
  s_mov_b32 exec_hi, 0
  global_load_dword v255, v3, s[70:71]
  s_mov_b32 exec_hi, -1
L_cpf_1:
  s_getreg_b32 s66, hwreg(HW_REG_XCC_ID, 0, 4)
  s_mov_b32 s68, 0xffff0000
  s_mov_b32 s30, 2097152
  s_mov_b32 s31, 0x20000
  s_mov_b32 s34, 1572864
  s_mov_b32 s35, 0x20000
  s_mov_b32 s38, 524288
  s_mov_b32 s39, 0x20000
  s_mov_b32 s42, 1835008
  s_mov_b32 s43, 0x20000
  s_mov_b32 s46, 1835008
  s_mov_b32 s47, 0x20000
  s_mov_b32 s50, 3145728
  s_mov_b32 s51, 0x20000
  s_mov_b32 s54, 16777216
  s_mov_b32 s55, 0x20000
  s_mov_b32 s58, 2097152
  s_mov_b32 s59, 0x20000
  v_lshrrev_b32 v5, 4, v1
  v_and_b32 v6, 15, v1
  s_lshl_b32 s26, s61, 6
  s_lshl_b32 s27, s60, 4
  s_add_u32 s26, s26, s27
  v_add_u32 v3, s26, v5
  v_lshlrev_b32 v3, 10, v3
  v_lshl_add_u32 v254, v6, 4, v3
  v_min_u32 v24, 1984, v253
  v_min_u32 v25, 1472, v253
  s_lshl3_add_u32 s26, s61, s62
  s_lshl2_add_u32 s26, s26, s60
  s_lshl_b32 s76, s26, 11
  s_lshl2_add_u32 s27, s2, s60
  s_mul_i32 s67, s27, 1536
  s_bfe_u32 s3, s2, 0x20005
  s_lshl_b32 s3, s3, 7
  s_lshl_b32 s69, s60, 5
  s_add_u32 s3, s3, s69
  v_lshrrev_b32 v3, 1, v1
  v_add_u32 v3, s3, v3
  v_lshlrev_b32 v4, 1, v3
  v_mul_u32_u24 v3, 384, v3
  v_and_or_b32 v3, v1, 1, v3
  v_lshlrev_b32 v3, 4, v3
  s_lshl_b32 s69, s64, 2
  s_and_b32 s3, s62, 3
  s_add_u32 s69, s69, s3
  s_lshl_b32 s69, s69, 5
  s_waitcnt lgkmcnt(0)
  s_mov_b64 s[48:49], s[18:19]
  s_mov_b64 s[28:29], s[4:5]
  s_mov_b64 s[32:33], s[6:7]
  buffer_load_dwordx4 v[224:227], v3, s[48:51], s69 offen offset:0
  global_load_ushort v20, v4, s[16:17] offset:0
  buffer_load_dword v255, v24, s[28:31], s76 offen
  s_load_dword s65, s[24:25], 0
  s_mov_b64 s[36:37], s[8:9]
  s_mov_b64 s[40:41], s[12:13]
  s_mov_b64 s[44:45], s[14:15]
  s_mov_b64 s[52:53], s[24:25]
  s_mov_b64 s[56:57], s[20:21]
  s_lshr_b32 s3, s63, 3
  s_cmp_gt_u32 s62, 3
  s_subb_u32 s63, s63, s3
  s_add_u32 s3, s3, 14
  s_cmp_eq_u32 s62, 3
  s_cselect_b32 s63, s3, s63
  s_lshl2_add_u32 s3, s62, s60
  s_lshl_b32 s4, s3, 17
  s_lshl_b32 s5, s61, 12
  s_add_u32 s4, s4, s5
  s_add_u32 s12, s4, 1048576
  s_lshl_b32 s4, s3, 7
  s_add_u32 s4, s4, s5
  s_add_u32 s13, s4, 65536
  s_lshl_b32 s8, s61, 16
  s_lshl_b32 s5, s3, 9
  s_add_u32 s4, s8, s5
  s_add_u32 s14, s4, 5242880
  s_lshl_b32 s4, s60, 14
  s_add_u32 s4, s4, s8
  s_add_u32 s19, s4, 5242880
  s_lshl_b32 s6, s61, 10
  s_add_u32 s18, s6, 196608
  s_lshl2_add_u32 s15, s3, s18
  s_lshr_b32 s11, s60, 1
  s_lshl1_add_u32 s7, s61, s11
  s_lshl_b32 s8, s7, 15
  s_and_b32 s10, s60, 1
  s_lshl1_add_u32 s9, s62, s10
  s_lshl_b32 s4, s62, 7
  s_add_u32 s4, s4, s19
  s_sub_u32 s21, s4, 5242880
  s_lshl4_add_u32 s4, s62, s10
  s_lshl_b32 s4, s4, 8
  s_add_u32 s4, s4, s8
  s_add_u32 s22, s4, 7340032
  s_lshl4_add_u32 s4, s7, s9
  s_lshl_b32 s4, s4, 7
  s_add_u32 s23, s4, 524288
  s_lshl4_add_u32 s4, s11, s9
  s_lshl2_add_u32 s4, s4, s18
  s_add_u32 s26, s4, 128
  s_mul_i32 s4, s11, 28672
  s_mul_i32 s5, s10, 13312
  s_add_u32 s4, s4, s5
  s_lshl_b32 s75, s4, 5
  s_mul_i32 s5, s61, 229376
  s_add_u32 s4, s4, s5
  s_add_u32 s74, s4, 9437184
  s_lshl_b32 s4, s10, 12
  s_add_u32 s20, s4, 2048
  buffer_load_dword v255, v25, s[32:35], s67 offen
  s_movk_i32 s4, 0
  buffer_load_dwordx4 v[144:147], v254, s[28:31], s4 offen offset:0
  buffer_load_dwordx4 v[148:151], v254, s[28:31], s4 offen offset:256
  buffer_load_dwordx4 v[152:155], v254, s[28:31], s4 offen offset:512
  buffer_load_dwordx4 v[156:159], v254, s[28:31], s4 offen offset:768
  s_lshl2_add_u32 s7, s64, s60
  s_lshr_b32 s6, s7, 1
  s_lshl_b32 s6, s6, 10
  s_lshl_b32 s4, s10, 6
  s_add_u32 s4, s4, s6
  s_add_u32 s27, s4, 196736
  s_lshl_b32 s4, s7, 11
  s_add_u32 s69, s4, 524288
  s_lshl_b32 s4, s7, 15
  s_add_u32 s70, s4, 7340032
  s_mul_i32 s4, s7, 114688
  s_lshl_b32 s5, s63, 12
  s_add_u32 s4, s4, s5
  s_add_u32 s71, s4, 9437184
  s_lshl1_add_u32 s5, s63, s10
  s_lshl2_add_u32 s4, s5, s6
  s_add_u32 s72, s4, 196864
  s_mul_i32 s4, s60, 6144
  s_add_u32 s77, s4, 131072
  s_lshr_b32 s4, s2, 3
  s_lshl2_add_u32 s0, s4, s60
  v_bfe_u32 v16, v1, 2, 3
  v_mul_u32_u24 v4, 3072, v16
  v_lshrrev_b32 v17, 5, v1
  v_lshl_add_u32 v4, v17, 6, v4
  v_and_b32 v3, 3, v1
  v_lshl_add_u32 v4, v3, 4, v4
  s_lshl_b32 s4, s62, 7
  v_add_u32 v244, s4, v4
  v_xor_b32 v4, 32, v244
  v_add_u32 v245, 23552, v4
  v_add_u32 v246, 47104, v244
  v_add_u32 v247, 70656, v4
  v_lshlrev_b32 v4, 10, v16
  v_lshl_add_u32 v4, v17, 6, v4
  v_lshl_add_u32 v4, v3, 4, v4
  v_add_u32 v12, s4, v4
  v_bfe_u32 v4, v1, 4, 1
  v_lshlrev_b32 v4, 5, v4
  v_xor_b32 v9, v4, v12
  v_add_u32 v10, 7168, v9
  v_add_u32 v12, 15360, v9
  v_mul_u32_u24 v4, 3584, v16
  v_lshl_add_u32 v4, v17, 6, v4
  v_lshl_add_u32 v4, v3, 4, v4
  s_lshl_b32 s4, s63, 8
  v_add_u32 v5, s4, v4
  v_add_u32 v6, 27648, v5
  v_add_u32 v7, 55296, v5
  v_add_u32 v8, 82944, v5
  v_lshrrev_b32 v4, 4, v1
  v_lshlrev_b32 v3, 10, v4
  v_xor_b32 v4, s60, v4
  v_and_b32 v4, 1, v4
  v_lshl_add_u32 v3, v4, 5, v3
  v_bfe_u32 v4, v1, 2, 2
  v_lshl_add_u32 v3, v4, 6, v3
  v_and_b32 v4, 3, v1
  v_lshl_add_u32 v3, v4, 3, v3
  s_lshr_b32 s3, s60, 1
  s_lshl_b32 s3, s3, 9
  v_add_u32 v252, s3, v3
  v_bfe_u32 v4, v1, 2, 2
  v_lshlrev_b32 v3, 6, v4
  v_bfe_u32 v4, v1, 4, 1
  v_lshl_add_u32 v3, v4, 5, v3
  v_and_b32 v4, 3, v1
  v_lshl_add_u32 v3, v4, 3, v3
  v_lshrrev_b32 v4, 5, v1
  v_lshl_add_u32 v13, v4, 8, v3
  v_and_b32 v16, 0xe0, v0
  v_and_b32 v17, 1, v0
  v_lshl_add_u32 v16, v17, 4, v16
  v_bfe_u32 v17, v0, 1, 4
  v_add_u32 v16, v16, v17
  v_lshlrev_b32 v16, 4, v16
  v_add_u32 v232, 131072, v16
  v_and_b32 v16, 15, v1
  v_lshlrev_b32 v16, 4, v16
  v_add_u32 v233, 131072, v16
  v_and_b32 v3, 15, v1
  v_lshl_add_u32 v3, v4, 4, v3
  v_lshlrev_b32 v15, 4, v3
  v_bfe_u32 v16, v1, 4, 1
  v_lshl_add_u32 v14, v16, 14, v15
  s_mul_i32 s5, s11, 6144
  s_lshl_b32 s4, s9, 7
  s_add_u32 s4, s4, s5
  v_and_b32 v17, 7, v1
  v_lshl_add_u32 v11, v17, 4, s4
  v_lshrrev_b32 v16, 4, v1
  v_and_b32 v4, 15, v1
  s_lshl_b32 s5, s60, 10
  v_and_b32 v17, 3, v4
  v_lshl_add_u32 v3, v17, 8, s5
  v_lshrrev_b32 v17, 2, v4
  v_lshl_add_u32 v3, v17, 12, v3
  v_and_b32 v4, 7, v4
  v_xor_b32 v4, v4, v16
  v_xor_b32 v16, 0, v4
  v_lshl_add_u32 v248, v16, 4, v3
  v_xor_b32 v16, 4, v4
  v_lshl_add_u32 v249, v16, 4, v3
  v_xor_b32 v16, 8, v4
  v_lshl_add_u32 v250, v16, 4, v3
  v_xor_b32 v16, 12, v4
  v_lshl_add_u32 v251, v16, 4, v3
  s_bfe_u32 s3, s2, 0x20005
  s_lshl_b32 s3, s3, 7
  s_lshl_b32 s1, s60, 5
  s_add_u32 s3, s3, s1
  v_lshrrev_b32 v234, 2, v1
  v_add_u32 v234, s3, v234
  v_lshlrev_b32 v235, 1, v234
  v_mul_u32_u24 v234, 384, v234
  v_and_or_b32 v234, v1, 3, v234
  v_lshlrev_b32 v234, 4, v234
  s_lshl_b32 s1, s64, 2
  s_and_b32 s3, s62, 3
  s_add_u32 s1, s1, s3
  s_lshl_b32 s1, s1, 6
  v_add_u32 v234, s1, v234
  s_lshl_b32 s73, s60, 12
  s_mul_i32 s11, s60, 98304
  v_lshrrev_b32 v16, 3, v1
  v_and_b32 v17, 0x70, v2
  v_lshl_add_u32 v231, v16, 10, v17
  v_min_u32 v229, 23, v1
  v_lshlrev_b32 v19, 9, v229
  v_and_b32 v229, 1, v229
  v_mul_u32_u24 v229, 448, v229
  v_sub_u32 v229, v19, v229
  s_mov_b64 exec, 0
  s_cmp_eq_u32 s60, 0
  s_cbranch_scc1 L_pad1
  s_cmp_eq_u32 s60, 1
  s_cbranch_scc1 L_pad2
  s_cmp_eq_u32 s60, 2
  s_cbranch_scc1 L_pad3
  s_branch L_pad4
L_gagain_4:
  s_add_u32 s8, s8, 1
  s_cmp_ge_u32 s8, 32768
  s_cbranch_scc1 L_gok_5
  s_mov_b32 s1, 262144
  buffer_load_dwordx4 v[144:147], v4, s[52:55], s1 offen sc1
  s_mov_b32 s1, 274432
  buffer_load_dwordx4 v[148:151], v4, s[52:55], s1 offen sc1
  s_mov_b32 s1, 286720
  buffer_load_dwordx4 v[152:155], v4, s[52:55], s1 offen sc1
  s_mov_b32 s1, 299008
  buffer_load_dwordx4 v[156:159], v4, s[52:55], s1 offen sc1
  s_waitcnt vmcnt(0)
  s_branch L_gchk_3
L_hagain_7:
  s_lshl_b32 s4, s64, 7
  s_add_u32 s4, s4, 4096
  s_mov_b32 s5, 0
L_hchk_8:
  buffer_load_dword v63, v50, s[52:55], s4 offen sc1
  s_add_u32 s5, s5, 1
  s_waitcnt vmcnt(0)
  v_cmp_ne_u32 vcc, s3, v63
  v_xor_b32 v63, s3, v63
  s_cmp_eq_u64 vcc, 0
  s_cselect_b32 s67, 1, 0
  v_cmp_lt_u32 vcc, 15, v63
  s_cmp_ge_u32 s5, 32768
  s_cbranch_vccz L_hok_9
  s_cbranch_scc0 L_hchk_8
  s_branch L_hok_9
L_ep_11:
  v_lshrrev_b32 v3, 2, v1
  v_lshlrev_b32 v3, 7, v3
  v_and_b32 v4, 3, v1
  v_lshl_add_u32 v3, v4, 4, v3
  s_mov_b32 s1, 4096
  s_mov_b32 s3, 0
L_epl_13:
  buffer_load_dwordx4 v[72:75], v3, s[52:55], s1 offen sc1
  s_add_u32 s3, s3, 1
  s_waitcnt vmcnt(0)
  v_xor_b32 v72, s65, v72
  v_xor_b32 v73, s65, v73
  v_xor_b32 v74, s65, v74
  v_xor_b32 v75, s65, v75
  v_or_b32 v72, v72, v73
  v_or3_b32 v72, v72, v74, v75
  v_cmp_lt_u32 vcc, 15, v72
  s_cmp_lt_u32 s3, 32768
  s_cbranch_vccz L_epd_14
  s_cbranch_scc1 L_epl_13
L_epd_14:
  v_mov_b32 v3, s65
  s_mov_b64 exec, 1
  buffer_store_dword v3, off, s[52:55], 0 offset:0 sc1
  s_mov_b64 exec, -1
  s_branch L_epb_12
L_kva_16:
  s_add_u32 s3, s3, 1
  s_cmp_ge_u32 s3, 32768
  s_cbranch_scc1 L_kvd_17
  s_load_dword s8, s[24:25], s4 glc
  s_load_dword s9, s[24:25], s5 glc
  s_load_dword s10, s[24:25], s6 glc
  s_load_dword s11, s[24:25], s7 glc
  s_branch L_kvp_15
L_gagain_21:
  s_add_u32 s8, s8, 1
  s_cmp_ge_u32 s8, 32768
  s_cbranch_scc1 L_gok_22
  s_mov_b32 s1, 268288
  buffer_load_dwordx4 v[112:115], v15, s[52:55], s1 offen sc1
  s_mov_b32 s1, 280576
  buffer_load_dwordx4 v[116:119], v15, s[52:55], s1 offen sc1
  s_mov_b32 s1, 292864
  buffer_load_dwordx4 v[120:123], v15, s[52:55], s1 offen sc1
  s_mov_b32 s1, 305152
  buffer_load_dwordx4 v[124:127], v15, s[52:55], s1 offen sc1
  s_mov_b32 s1, 266240
  buffer_load_dwordx4 v[128:131], v11, s[52:55], s1 offen sc1
  s_mov_b32 s1, 278528
  buffer_load_dwordx4 v[132:135], v11, s[52:55], s1 offen sc1
  s_mov_b32 s1, 290816
  buffer_load_dwordx4 v[136:139], v11, s[52:55], s1 offen sc1
  s_mov_b32 s1, 303104
  buffer_load_dwordx4 v[140:143], v11, s[52:55], s1 offen sc1
  s_waitcnt vmcnt(0)
  s_branch L_gchk_20
L_pagain_25:
  s_mov_b32 s1, 0
L_pchk_26:
  buffer_load_dword v3, v252, s[52:55], s18 offen offset:0 sc1
  s_add_u32 s1, s1, 1
  s_waitcnt vmcnt(0)
  v_cmp_ne_u32 vcc, s65, v3
  s_cmp_ge_u32 s1, 32768
  s_cbranch_vccz L_pok_27
  s_cbranch_scc0 L_pchk_26
  s_branch L_pok_27
L_pagain_30:
  s_mov_b32 s1, 0
L_pchk_31:
  buffer_load_dword v3, v254, s[52:55], s27 offen offset:0 sc1
  s_add_u32 s1, s1, 1
  s_waitcnt vmcnt(0)
  v_cmp_ne_u32 vcc, s65, v3
  s_cmp_ge_u32 s1, 32768
  s_cbranch_vccz L_pok_32
  s_cbranch_scc0 L_pchk_31
  s_branch L_pok_32
L_pagain_35:
  s_mov_b32 s1, 0
L_pchk_36:
  buffer_load_dword v255, v251, s[52:55], s18 offen offset:256 sc1
  s_add_u32 s1, s1, 1
  s_waitcnt vmcnt(0)
  v_cmp_ne_u32 vcc, s65, v255
  s_cmp_ge_u32 s1, 32768
  s_cbranch_vccz L_pok_37
  s_cbranch_scc0 L_pchk_36
  s_branch L_pok_37
L_pagain_42:
  s_mov_b32 s1, 0
L_pchk_43:
  buffer_load_dword v255, v251, s[52:55], s18 offen offset:384 sc1
  s_add_u32 s1, s1, 1
  s_waitcnt vmcnt(0)
  v_cmp_ne_u32 vcc, s65, v255
  s_cmp_ge_u32 s1, 32768
  s_cbranch_vccz L_pok_44
  s_cbranch_scc0 L_pchk_43
  s_branch L_pok_44
L_pagain_45:
  s_mov_b32 s1, 0
L_pchk_46:
  buffer_load_dword v255, v251, s[52:55], s18 offen offset:512 sc1
  s_add_u32 s1, s1, 1
  s_waitcnt vmcnt(0)
  v_cmp_ne_u32 vcc, s65, v255
  s_cmp_ge_u32 s1, 32768
  s_cbranch_vccz L_pok_47
  s_cbranch_scc0 L_pchk_46
  s_branch L_pok_47
  .p2align 12
L_body:
  s_mov_b64 exec, -1
  s_movk_i32 s4, 4096
  buffer_load_dwordx4 v[160:163], v254, s[28:31], s4 offen offset:0
  buffer_load_dwordx4 v[164:167], v254, s[28:31], s4 offen offset:256
  buffer_load_dwordx4 v[168:171], v254, s[28:31], s4 offen offset:512
  buffer_load_dwordx4 v[172:175], v254, s[28:31], s4 offen offset:768
  s_waitcnt lgkmcnt(0)
  s_add_u32 s65, s65, 0x9e3779b1
  s_bfe_u32 s5, s2, 0x20005
  s_mul_i32 s5, s5, 12288
  s_and_b32 s3, s62, 3
  s_lshl2_add_u32 s8, s64, s3
  s_lshl_b32 s8, s8, 6
  s_add_u32 s8, s8, s5
  s_add_u32 s8, s8, 262144
  v_mov_b32 v28, s65
  v_lshrrev_b32 v29, 8, v28
  v_lshrrev_b32 v30, 16, v28
  v_lshrrev_b32 v31, 24, v28
  s_waitcnt vmcnt(10)
  v_lshlrev_b32 v20, 16, v20
  v_mul_f32 v22, 0xbfb8aa3b, v20
  v_exp_f32 v22, v22
  v_lshlrev_b32 v208, 16, v224
  v_and_b32 v209, s68, v224
  v_add_f32 v22, 1.0, v22
  v_rcp_f32 v22, v22
  v_lshlrev_b32 v210, 16, v225
  v_and_b32 v211, s68, v225
  v_mul_f32 v20, v20, v22
  v_cvt_pk_bf16_f32 v20, v20, v20
  v_and_b32 v20, s68, v20
  v_lshlrev_b32 v212, 16, v226
  v_and_b32 v213, s68, v226
  v_lshlrev_b32 v214, 16, v227
  v_and_b32 v215, s68, v227
  v_pk_mul_f32 v[236:237], v[208:209], v[20:21] op_sel_hi:[1,0]
  v_pk_mul_f32 v[238:239], v[210:211], v[20:21] op_sel_hi:[1,0]
  v_pk_mul_f32 v[240:241], v[212:213], v[20:21] op_sel_hi:[1,0]
  v_pk_mul_f32 v[242:243], v[214:215], v[20:21] op_sel_hi:[1,0]
  v_and_b32 v3, 1, v1
  v_lshlrev_b32 v3, 5, v3
  v_permlane32_swap_b32 v236, v240
  v_permlane32_swap_b32 v237, v241
  v_permlane32_swap_b32 v238, v242
  v_permlane32_swap_b32 v239, v243
  v_pk_add_f32 v[236:237], v[236:237], v[240:241]
  v_pk_add_f32 v[238:239], v[238:239], v[242:243]
  v_lshrrev_b32 v4, 4, v1
  v_lshl_add_u32 v3, v4, 3, v3
  v_permlane16_swap_b32 v236, v238
  v_permlane16_swap_b32 v237, v239
  v_pk_add_f32 v[236:237], v[236:237], v[238:239]
  s_lshl_b32 s5, s60, 6
  s_add_u32 s5, s5, 135168
  v_add_f32_dpp v236, v236, v236 row_ror:8 row_mask:0xf bank_mask:0xf
  v_add_f32_dpp v237, v237, v237 row_ror:8 row_mask:0xf bank_mask:0xf
  v_add_u32 v3, s5, v3
  v_add_f32_dpp v236, v236, v236 row_ror:4 row_mask:0xf bank_mask:0xf
  v_add_f32_dpp v237, v237, v237 row_ror:4 row_mask:0xf bank_mask:0xf
  v_and_b32 v4, 3, v1
  v_add_f32_dpp v236, v236, v236 row_ror:2 row_mask:0xf bank_mask:0xf
  v_add_f32_dpp v237, v237, v237 row_ror:2 row_mask:0xf bank_mask:0xf
  v_lshlrev_b32 v4, 4, v4
  ds_write_b64 v3, v[236:237]
  v_add_u32 v3, 135168, v4
  s_movk_i32 s76, 8192
  buffer_load_dwordx4 v[176:179], v254, s[28:31], s76 offen offset:0
  buffer_load_dwordx4 v[180:183], v254, s[28:31], s76 offen offset:256
  buffer_load_dwordx4 v[184:187], v254, s[28:31], s76 offen offset:512
  buffer_load_dwordx4 v[188:191], v254, s[28:31], s76 offen offset:768
  s_movk_i32 s76, 12288
  s_waitcnt lgkmcnt(0)
  s_barrier
  s_cmp_lg_u32 s60, 0
  s_cbranch_scc1 L_cw_2
  ds_read_b128 v[208:211], v3 offset:0
  ds_read_b128 v[212:215], v3 offset:64
  ds_read_b128 v[216:219], v3 offset:128
  ds_read_b128 v[220:223], v3 offset:192
  s_movk_i32 s5, 0xff
  s_waitcnt lgkmcnt(0)
  v_pk_add_f32 v[208:209], v[208:209], v[212:213]
  v_pk_add_f32 v[216:217], v[216:217], v[220:221]
  v_pk_add_f32 v[210:211], v[210:211], v[214:215]
  v_pk_add_f32 v[218:219], v[218:219], v[222:223]
  v_pk_add_f32 v[208:209], v[208:209], v[216:217]
  v_pk_add_f32 v[210:211], v[210:211], v[218:219]
  v_bfi_b32 v236, s5, v28, v208
  v_bfi_b32 v237, s5, v29, v209
  v_bfi_b32 v238, s5, v30, v210
  v_bfi_b32 v239, s5, v31, v211
  s_mov_b64 exec, 15
  buffer_store_dwordx4 v[236:239], v4, s[52:55], s8 offen sc1
  s_mov_b64 exec, -1
  s_nop 1
L_cw_2:
  buffer_load_dwordx4 v[192:195], v254, s[28:31], s76 offen offset:0
  buffer_load_dwordx4 v[196:199], v254, s[28:31], s76 offen offset:256
  buffer_load_dwordx4 v[200:203], v254, s[28:31], s76 offen offset:512
  buffer_load_dwordx4 v[204:207], v254, s[28:31], s76 offen offset:768
  s_mov_b32 s9, 0x3b000000
  s_mov_b32 s10, 0x3f803f80
  s_mov_b32 s7, 0x3f80
  s_mov_b32 s6, 0x3f800000
  v_mov_b32 v228, 0x3727c5ac
  s_waitcnt vmcnt(12)
  v_dot2_f32_bf16 v216, v144, s10, 0
  v_dot2_f32_bf16 v216, v145, s10, v216
  v_dot2_f32_bf16 v216, v146, s10, v216
  v_dot2_f32_bf16 v216, v147, s10, v216
  v_dot2_f32_bf16 v216, v148, s10, v216
  v_dot2_f32_bf16 v216, v149, s10, v216
  v_dot2_f32_bf16 v216, v150, s10, v216
  v_dot2_f32_bf16 v216, v151, s10, v216
  buffer_load_dwordx4 v[208:211], v231, s[28:31], s21 offen
  s_add_u32 s1, s21, 8192
  v_dot2_f32_bf16 v216, v152, s10, v216
  v_dot2_f32_bf16 v216, v153, s10, v216
  v_dot2_f32_bf16 v216, v154, s10, v216
  v_dot2_f32_bf16 v216, v155, s10, v216
  v_dot2_f32_bf16 v216, v156, s10, v216
  v_dot2_f32_bf16 v216, v157, s10, v216
  v_dot2_f32_bf16 v216, v158, s10, v216
  v_dot2_f32_bf16 v216, v159, s10, v216
  s_waitcnt vmcnt(9)
  v_dot2_f32_bf16 v220, v160, s10, 0
  v_dot2_f32_bf16 v220, v161, s10, v220
  v_dot2_f32_bf16 v220, v162, s10, v220
  v_dot2_f32_bf16 v220, v163, s10, v220
  buffer_load_dwordx4 v[212:215], v231, s[28:31], s1 offen
  s_mul_i32 s1, s0, 12288
  v_dot2_f32_bf16 v220, v164, s10, v220
  v_dot2_f32_bf16 v220, v165, s10, v220
  v_dot2_f32_bf16 v220, v166, s10, v220
  v_dot2_f32_bf16 v220, v167, s10, v220
  v_dot2_f32_bf16 v220, v168, s10, v220
  v_dot2_f32_bf16 v220, v169, s10, v220
  v_dot2_f32_bf16 v220, v170, s10, v220
  v_dot2_f32_bf16 v220, v171, s10, v220
  v_dot2_f32_bf16 v220, v172, s10, v220
  v_dot2_f32_bf16 v220, v173, s10, v220
  v_dot2_f32_bf16 v220, v174, s10, v220
  v_dot2_f32_bf16 v220, v175, s10, v220
  v_add_f32_dpp v216, v216, v216 row_ror:8 row_mask:0xf bank_mask:0xf
  buffer_load_dword v255, v229, s[32:35], s1 offen offset:384
  s_add_u32 m0, s73, 0
  s_add_u32 s76, s11, 1024
  v_add_f32_dpp v220, v220, v220 row_ror:8 row_mask:0xf bank_mask:0xf
  v_add_f32_dpp v216, v216, v216 row_ror:4 row_mask:0xf bank_mask:0xf
  s_nop 0
  v_add_f32_dpp v220, v220, v220 row_ror:4 row_mask:0xf bank_mask:0xf
  v_add_f32_dpp v216, v216, v216 row_ror:2 row_mask:0xf bank_mask:0xf
  s_nop 0
  v_add_f32_dpp v220, v220, v220 row_ror:2 row_mask:0xf bank_mask:0xf
  v_add_f32_dpp v216, v216, v216 row_ror:1 row_mask:0xf bank_mask:0xf
  s_nop 0
  v_add_f32_dpp v220, v220, v220 row_ror:1 row_mask:0xf bank_mask:0xf
  v_mul_f32 v224, 0xbb000000, v216
  v_mul_f32 v225, 0xbb000000, v220
  v_dot2_f32_bf16 v16, v144, s7, v224
  v_dot2_f32_bf16 v17, v144, s6, v224
  v_dot2_f32_bf16 v18, v145, s7, v224
  buffer_load_dwordx4 v244, s[32:35], s76 offen offset:0  lds
  v_dot2_f32_bf16 v19, v145, s6, v224
  v_dot2_f32_bf16 v20, v146, s7, v224
  v_dot2_f32_bf16 v21, v146, s6, v224
  v_dot2_f32_bf16 v22, v147, s7, v224
  v_dot2_f32_bf16 v23, v147, s6, v224
  v_dot2_f32_bf16 v24, v148, s7, v224
  v_dot2_f32_bf16 v25, v148, s6, v224
  v_dot2_f32_bf16 v26, v149, s7, v224
  v_dot2_f32_bf16 v27, v149, s6, v224
  v_dot2_f32_bf16 v28, v150, s7, v224
  v_dot2_f32_bf16 v29, v150, s6, v224
  v_dot2_f32_bf16 v30, v151, s7, v224
  v_dot2_f32_bf16 v31, v151, s6, v224
  v_dot2_f32_bf16 v32, v152, s7, v224
  buffer_load_dwordx4 v245, s[32:35], s76 offen offset:1024  lds
  v_dot2_f32_bf16 v33, v152, s6, v224
  v_dot2_f32_bf16 v34, v153, s7, v224
  v_dot2_f32_bf16 v35, v153, s6, v224
  v_dot2_f32_bf16 v36, v154, s7, v224
  v_dot2_f32_bf16 v37, v154, s6, v224
  v_dot2_f32_bf16 v38, v155, s7, v224
  v_dot2_f32_bf16 v39, v155, s6, v224
  v_dot2_f32_bf16 v40, v156, s7, v224
  v_dot2_f32_bf16 v41, v156, s6, v224
  v_dot2_f32_bf16 v42, v157, s7, v224
  v_dot2_f32_bf16 v43, v157, s6, v224
  v_dot2_f32_bf16 v44, v158, s7, v224
  v_dot2_f32_bf16 v45, v158, s6, v224
  v_dot2_f32_bf16 v46, v159, s7, v224
  buffer_load_dwordx4 v246, s[32:35], s76 offen offset:2048  lds
  v_dot2_f32_bf16 v47, v159, s6, v224
  v_pk_mul_f32 v[216:217], v[16:17], v[16:17]
  v_pk_mul_f32 v[218:219], v[18:19], v[18:19]
  v_pk_fma_f32 v[216:217], v[20:21], v[20:21], v[216:217]
  v_pk_fma_f32 v[218:219], v[22:23], v[22:23], v[218:219]
  v_pk_fma_f32 v[216:217], v[24:25], v[24:25], v[216:217]
  v_pk_fma_f32 v[218:219], v[26:27], v[26:27], v[218:219]
  v_pk_fma_f32 v[216:217], v[28:29], v[28:29], v[216:217]
  v_pk_fma_f32 v[218:219], v[30:31], v[30:31], v[218:219]
  v_pk_fma_f32 v[216:217], v[32:33], v[32:33], v[216:217]
  v_pk_fma_f32 v[218:219], v[34:35], v[34:35], v[218:219]
  v_pk_fma_f32 v[216:217], v[36:37], v[36:37], v[216:217]
  v_pk_fma_f32 v[218:219], v[38:39], v[38:39], v[218:219]
  v_pk_fma_f32 v[216:217], v[40:41], v[40:41], v[216:217]
  buffer_load_dwordx4 v247, s[32:35], s76 offen offset:3072  lds
  s_add_u32 m0, s73, 16384
  s_add_u32 s76, s11, 394240
  v_pk_fma_f32 v[218:219], v[42:43], v[42:43], v[218:219]
  v_pk_fma_f32 v[216:217], v[44:45], v[44:45], v[216:217]
  v_pk_fma_f32 v[218:219], v[46:47], v[46:47], v[218:219]
  v_pk_add_f32 v[216:217], v[216:217], v[218:219]
  v_add_f32 v216, v216, v217
  v_dot2_f32_bf16 v48, v160, s7, v225
  v_dot2_f32_bf16 v49, v160, s6, v225
  v_dot2_f32_bf16 v50, v161, s7, v225
  v_dot2_f32_bf16 v51, v161, s6, v225
  v_dot2_f32_bf16 v52, v162, s7, v225
  v_dot2_f32_bf16 v53, v162, s6, v225
  v_dot2_f32_bf16 v54, v163, s7, v225
  buffer_load_dwordx4 v244, s[32:35], s76 offen offset:0  lds
  v_dot2_f32_bf16 v55, v163, s6, v225
  v_dot2_f32_bf16 v56, v164, s7, v225
  v_dot2_f32_bf16 v57, v164, s6, v225
  v_dot2_f32_bf16 v58, v165, s7, v225
  v_dot2_f32_bf16 v59, v165, s6, v225
  v_dot2_f32_bf16 v60, v166, s7, v225
  v_dot2_f32_bf16 v61, v166, s6, v225
  v_dot2_f32_bf16 v62, v167, s7, v225
  v_dot2_f32_bf16 v63, v167, s6, v225
  v_dot2_f32_bf16 v64, v168, s7, v225
  v_dot2_f32_bf16 v65, v168, s6, v225
  v_dot2_f32_bf16 v66, v169, s7, v225
  v_dot2_f32_bf16 v67, v169, s6, v225
  v_dot2_f32_bf16 v68, v170, s7, v225
  buffer_load_dwordx4 v245, s[32:35], s76 offen offset:1024  lds
  v_dot2_f32_bf16 v69, v170, s6, v225
  v_dot2_f32_bf16 v70, v171, s7, v225
  v_dot2_f32_bf16 v71, v171, s6, v225
  v_dot2_f32_bf16 v72, v172, s7, v225
  v_dot2_f32_bf16 v73, v172, s6, v225
  v_dot2_f32_bf16 v74, v173, s7, v225
  v_dot2_f32_bf16 v75, v173, s6, v225
  v_dot2_f32_bf16 v76, v174, s7, v225
  v_dot2_f32_bf16 v77, v174, s6, v225
  v_dot2_f32_bf16 v78, v175, s7, v225
  v_dot2_f32_bf16 v79, v175, s6, v225
  v_pk_mul_f32 v[220:221], v[48:49], v[48:49]
  v_pk_mul_f32 v[222:223], v[50:51], v[50:51]
  v_pk_fma_f32 v[220:221], v[52:53], v[52:53], v[220:221]
  buffer_load_dwordx4 v246, s[32:35], s76 offen offset:2048  lds
  v_pk_fma_f32 v[222:223], v[54:55], v[54:55], v[222:223]
  v_pk_fma_f32 v[220:221], v[56:57], v[56:57], v[220:221]
  v_pk_fma_f32 v[222:223], v[58:59], v[58:59], v[222:223]
  v_pk_fma_f32 v[220:221], v[60:61], v[60:61], v[220:221]
  v_pk_fma_f32 v[222:223], v[62:63], v[62:63], v[222:223]
  v_pk_fma_f32 v[220:221], v[64:65], v[64:65], v[220:221]
  v_pk_fma_f32 v[222:223], v[66:67], v[66:67], v[222:223]
  v_pk_fma_f32 v[220:221], v[68:69], v[68:69], v[220:221]
  v_pk_fma_f32 v[222:223], v[70:71], v[70:71], v[222:223]
  v_pk_fma_f32 v[220:221], v[72:73], v[72:73], v[220:221]
  v_pk_fma_f32 v[222:223], v[74:75], v[74:75], v[222:223]
  v_pk_fma_f32 v[220:221], v[76:77], v[76:77], v[220:221]
  v_pk_fma_f32 v[222:223], v[78:79], v[78:79], v[222:223]
  v_pk_add_f32 v[220:221], v[220:221], v[222:223]
  buffer_load_dwordx4 v247, s[32:35], s76 offen offset:3072  lds
  s_add_u32 m0, s73, 32768
  s_add_u32 s76, s11, 787456
  v_add_f32 v220, v220, v221
  v_add_f32_dpp v216, v216, v216 row_ror:8 row_mask:0xf bank_mask:0xf
  s_nop 0
  v_add_f32_dpp v220, v220, v220 row_ror:8 row_mask:0xf bank_mask:0xf
  v_add_f32_dpp v216, v216, v216 row_ror:4 row_mask:0xf bank_mask:0xf
  s_nop 0
  v_add_f32_dpp v220, v220, v220 row_ror:4 row_mask:0xf bank_mask:0xf
  v_add_f32_dpp v216, v216, v216 row_ror:2 row_mask:0xf bank_mask:0xf
  s_nop 0
  v_add_f32_dpp v220, v220, v220 row_ror:2 row_mask:0xf bank_mask:0xf
  v_add_f32_dpp v216, v216, v216 row_ror:1 row_mask:0xf bank_mask:0xf
  s_nop 0
  v_add_f32_dpp v220, v220, v220 row_ror:1 row_mask:0xf bank_mask:0xf
  v_fma_f32 v224, v216, s9, v228
  v_fma_f32 v225, v220, s9, v228
  v_rsq_f32 v224, v224
  buffer_load_dwordx4 v244, s[32:35], s76 offen offset:0  lds
  v_rsq_f32 v225, v225
  s_nop 0
  v_pk_mul_f32 v[16:17], v[16:17], v[224:225] op_sel:[0,0] op_sel_hi:[1,0]
  v_pk_mul_f32 v[18:19], v[18:19], v[224:225] op_sel:[0,0] op_sel_hi:[1,0]
  v_pk_mul_f32 v[20:21], v[20:21], v[224:225] op_sel:[0,0] op_sel_hi:[1,0]
  v_pk_mul_f32 v[22:23], v[22:23], v[224:225] op_sel:[0,0] op_sel_hi:[1,0]
  v_pk_mul_f32 v[24:25], v[24:25], v[224:225] op_sel:[0,0] op_sel_hi:[1,0]
  v_pk_mul_f32 v[26:27], v[26:27], v[224:225] op_sel:[0,0] op_sel_hi:[1,0]
  v_pk_mul_f32 v[28:29], v[28:29], v[224:225] op_sel:[0,0] op_sel_hi:[1,0]
  v_pk_mul_f32 v[30:31], v[30:31], v[224:225] op_sel:[0,0] op_sel_hi:[1,0]
  v_pk_mul_f32 v[32:33], v[32:33], v[224:225] op_sel:[0,0] op_sel_hi:[1,0]
  v_pk_mul_f32 v[34:35], v[34:35], v[224:225] op_sel:[0,0] op_sel_hi:[1,0]
  v_pk_mul_f32 v[36:37], v[36:37], v[224:225] op_sel:[0,0] op_sel_hi:[1,0]
  v_pk_mul_f32 v[38:39], v[38:39], v[224:225] op_sel:[0,0] op_sel_hi:[1,0]
  buffer_load_dwordx4 v245, s[32:35], s76 offen offset:1024  lds
  v_pk_mul_f32 v[40:41], v[40:41], v[224:225] op_sel:[0,0] op_sel_hi:[1,0]
  v_pk_mul_f32 v[42:43], v[42:43], v[224:225] op_sel:[0,0] op_sel_hi:[1,0]
  v_pk_mul_f32 v[44:45], v[44:45], v[224:225] op_sel:[0,0] op_sel_hi:[1,0]
  v_pk_mul_f32 v[46:47], v[46:47], v[224:225] op_sel:[0,0] op_sel_hi:[1,0]
  v_pk_mul_f32 v[48:49], v[48:49], v[224:225] op_sel:[0,1] op_sel_hi:[1,1]
  v_pk_mul_f32 v[50:51], v[50:51], v[224:225] op_sel:[0,1] op_sel_hi:[1,1]
  v_pk_mul_f32 v[52:53], v[52:53], v[224:225] op_sel:[0,1] op_sel_hi:[1,1]
  v_pk_mul_f32 v[54:55], v[54:55], v[224:225] op_sel:[0,1] op_sel_hi:[1,1]
  v_pk_mul_f32 v[56:57], v[56:57], v[224:225] op_sel:[0,1] op_sel_hi:[1,1]
  v_pk_mul_f32 v[58:59], v[58:59], v[224:225] op_sel:[0,1] op_sel_hi:[1,1]
  v_pk_mul_f32 v[60:61], v[60:61], v[224:225] op_sel:[0,1] op_sel_hi:[1,1]
  v_pk_mul_f32 v[62:63], v[62:63], v[224:225] op_sel:[0,1] op_sel_hi:[1,1]
  v_pk_mul_f32 v[64:65], v[64:65], v[224:225] op_sel:[0,1] op_sel_hi:[1,1]
  v_pk_mul_f32 v[66:67], v[66:67], v[224:225] op_sel:[0,1] op_sel_hi:[1,1]
  buffer_load_dwordx4 v246, s[32:35], s76 offen offset:2048  lds
  v_pk_mul_f32 v[68:69], v[68:69], v[224:225] op_sel:[0,1] op_sel_hi:[1,1]
  v_pk_mul_f32 v[70:71], v[70:71], v[224:225] op_sel:[0,1] op_sel_hi:[1,1]
  v_pk_mul_f32 v[72:73], v[72:73], v[224:225] op_sel:[0,1] op_sel_hi:[1,1]
  v_pk_mul_f32 v[74:75], v[74:75], v[224:225] op_sel:[0,1] op_sel_hi:[1,1]
  v_pk_mul_f32 v[76:77], v[76:77], v[224:225] op_sel:[0,1] op_sel_hi:[1,1]
  v_pk_mul_f32 v[78:79], v[78:79], v[224:225] op_sel:[0,1] op_sel_hi:[1,1]
  s_waitcnt vmcnt(18)
  v_dot2_f32_bf16 v216, v176, s10, 0
  v_dot2_f32_bf16 v216, v177, s10, v216
  v_dot2_f32_bf16 v216, v178, s10, v216
  v_dot2_f32_bf16 v216, v179, s10, v216
  v_dot2_f32_bf16 v216, v180, s10, v216
  v_dot2_f32_bf16 v216, v181, s10, v216
  v_dot2_f32_bf16 v216, v182, s10, v216
  buffer_load_dwordx4 v247, s[32:35], s76 offen offset:3072  lds
  s_add_u32 m0, s73, 49152
  s_add_u32 s76, s11, 1180672
  v_dot2_f32_bf16 v216, v183, s10, v216
  v_dot2_f32_bf16 v216, v184, s10, v216
  v_dot2_f32_bf16 v216, v185, s10, v216
  v_dot2_f32_bf16 v216, v186, s10, v216
  v_dot2_f32_bf16 v216, v187, s10, v216
  v_dot2_f32_bf16 v216, v188, s10, v216
  v_dot2_f32_bf16 v216, v189, s10, v216
  v_dot2_f32_bf16 v216, v190, s10, v216
  v_dot2_f32_bf16 v216, v191, s10, v216
  s_waitcnt vmcnt(15)
  v_dot2_f32_bf16 v220, v192, s10, 0
  v_dot2_f32_bf16 v220, v193, s10, v220
  buffer_load_dwordx4 v244, s[32:35], s76 offen offset:0  lds
  v_dot2_f32_bf16 v220, v194, s10, v220
  v_dot2_f32_bf16 v220, v195, s10, v220
  v_dot2_f32_bf16 v220, v196, s10, v220
  v_dot2_f32_bf16 v220, v197, s10, v220
  v_dot2_f32_bf16 v220, v198, s10, v220
  v_dot2_f32_bf16 v220, v199, s10, v220
  v_dot2_f32_bf16 v220, v200, s10, v220
  v_dot2_f32_bf16 v220, v201, s10, v220
  v_dot2_f32_bf16 v220, v202, s10, v220
  v_dot2_f32_bf16 v220, v203, s10, v220
  v_dot2_f32_bf16 v220, v204, s10, v220
  v_dot2_f32_bf16 v220, v205, s10, v220
  v_dot2_f32_bf16 v220, v206, s10, v220
  v_dot2_f32_bf16 v220, v207, s10, v220
  buffer_load_dwordx4 v245, s[32:35], s76 offen offset:1024  lds
  v_add_f32_dpp v216, v216, v216 row_ror:8 row_mask:0xf bank_mask:0xf
  s_nop 0
  v_add_f32_dpp v220, v220, v220 row_ror:8 row_mask:0xf bank_mask:0xf
  v_add_f32_dpp v216, v216, v216 row_ror:4 row_mask:0xf bank_mask:0xf
  s_nop 0
  v_add_f32_dpp v220, v220, v220 row_ror:4 row_mask:0xf bank_mask:0xf
  v_add_f32_dpp v216, v216, v216 row_ror:2 row_mask:0xf bank_mask:0xf
  s_nop 0
  v_add_f32_dpp v220, v220, v220 row_ror:2 row_mask:0xf bank_mask:0xf
  v_add_f32_dpp v216, v216, v216 row_ror:1 row_mask:0xf bank_mask:0xf
  s_nop 0
  v_add_f32_dpp v220, v220, v220 row_ror:1 row_mask:0xf bank_mask:0xf
  v_mul_f32 v226, 0xbb000000, v216
  v_mul_f32 v227, 0xbb000000, v220
  v_dot2_f32_bf16 v80, v176, s7, v226
  v_dot2_f32_bf16 v81, v176, s6, v226
  v_dot2_f32_bf16 v82, v177, s7, v226
  v_dot2_f32_bf16 v83, v177, s6, v226
  buffer_load_dwordx4 v246, s[32:35], s76 offen offset:2048  lds
  v_dot2_f32_bf16 v84, v178, s7, v226
  v_dot2_f32_bf16 v85, v178, s6, v226
  v_dot2_f32_bf16 v86, v179, s7, v226
  v_dot2_f32_bf16 v87, v179, s6, v226
  v_dot2_f32_bf16 v88, v180, s7, v226
  v_dot2_f32_bf16 v89, v180, s6, v226
  v_dot2_f32_bf16 v90, v181, s7, v226
  v_dot2_f32_bf16 v91, v181, s6, v226
  v_dot2_f32_bf16 v92, v182, s7, v226
  v_dot2_f32_bf16 v93, v182, s6, v226
  v_dot2_f32_bf16 v94, v183, s7, v226
  v_dot2_f32_bf16 v95, v183, s6, v226
  v_dot2_f32_bf16 v96, v184, s7, v226
  v_dot2_f32_bf16 v97, v184, s6, v226
  buffer_load_dwordx4 v247, s[32:35], s76 offen offset:3072  lds
  v_dot2_f32_bf16 v98, v185, s7, v226
  v_dot2_f32_bf16 v99, v185, s6, v226
  v_dot2_f32_bf16 v100, v186, s7, v226
  v_dot2_f32_bf16 v101, v186, s6, v226
  v_dot2_f32_bf16 v102, v187, s7, v226
  v_dot2_f32_bf16 v103, v187, s6, v226
  v_dot2_f32_bf16 v104, v188, s7, v226
  v_dot2_f32_bf16 v105, v188, s6, v226
  v_dot2_f32_bf16 v106, v189, s7, v226
  v_dot2_f32_bf16 v107, v189, s6, v226
  v_dot2_f32_bf16 v108, v190, s7, v226
  v_dot2_f32_bf16 v109, v190, s6, v226
  v_dot2_f32_bf16 v110, v191, s7, v226
  v_dot2_f32_bf16 v111, v191, s6, v226
  v_pk_mul_f32 v[216:217], v[80:81], v[80:81]
  v_pk_mul_f32 v[218:219], v[82:83], v[82:83]
  v_pk_fma_f32 v[216:217], v[84:85], v[84:85], v[216:217]
  v_pk_fma_f32 v[218:219], v[86:87], v[86:87], v[218:219]
  v_pk_fma_f32 v[216:217], v[88:89], v[88:89], v[216:217]
  v_pk_fma_f32 v[218:219], v[90:91], v[90:91], v[218:219]
  v_pk_fma_f32 v[216:217], v[92:93], v[92:93], v[216:217]
  v_pk_fma_f32 v[218:219], v[94:95], v[94:95], v[218:219]
  v_pk_fma_f32 v[216:217], v[96:97], v[96:97], v[216:217]
  v_pk_fma_f32 v[218:219], v[98:99], v[98:99], v[218:219]
  v_pk_fma_f32 v[216:217], v[100:101], v[100:101], v[216:217]
  v_pk_fma_f32 v[218:219], v[102:103], v[102:103], v[218:219]
  v_pk_fma_f32 v[216:217], v[104:105], v[104:105], v[216:217]
  v_pk_fma_f32 v[218:219], v[106:107], v[106:107], v[218:219]
  v_pk_fma_f32 v[216:217], v[108:109], v[108:109], v[216:217]
  v_pk_fma_f32 v[218:219], v[110:111], v[110:111], v[218:219]
  v_pk_add_f32 v[216:217], v[216:217], v[218:219]
  v_add_f32 v216, v216, v217
  v_dot2_f32_bf16 v112, v192, s7, v227
  v_dot2_f32_bf16 v113, v192, s6, v227
  v_dot2_f32_bf16 v114, v193, s7, v227
  v_dot2_f32_bf16 v115, v193, s6, v227
  v_dot2_f32_bf16 v116, v194, s7, v227
  v_dot2_f32_bf16 v117, v194, s6, v227
  v_dot2_f32_bf16 v118, v195, s7, v227
  v_dot2_f32_bf16 v119, v195, s6, v227
  v_dot2_f32_bf16 v120, v196, s7, v227
  v_dot2_f32_bf16 v121, v196, s6, v227
  v_dot2_f32_bf16 v122, v197, s7, v227
  v_dot2_f32_bf16 v123, v197, s6, v227
  v_dot2_f32_bf16 v124, v198, s7, v227
  v_dot2_f32_bf16 v125, v198, s6, v227
  v_dot2_f32_bf16 v126, v199, s7, v227
  v_dot2_f32_bf16 v127, v199, s6, v227
  v_dot2_f32_bf16 v128, v200, s7, v227
  v_dot2_f32_bf16 v129, v200, s6, v227
  v_dot2_f32_bf16 v130, v201, s7, v227
  v_dot2_f32_bf16 v131, v201, s6, v227
  v_dot2_f32_bf16 v132, v202, s7, v227
  v_dot2_f32_bf16 v133, v202, s6, v227
  v_dot2_f32_bf16 v134, v203, s7, v227
  v_dot2_f32_bf16 v135, v203, s6, v227
  v_dot2_f32_bf16 v136, v204, s7, v227
  v_dot2_f32_bf16 v137, v204, s6, v227
  v_dot2_f32_bf16 v138, v205, s7, v227
  v_dot2_f32_bf16 v139, v205, s6, v227
  v_dot2_f32_bf16 v140, v206, s7, v227
  v_dot2_f32_bf16 v141, v206, s6, v227
  v_dot2_f32_bf16 v142, v207, s7, v227
  v_dot2_f32_bf16 v143, v207, s6, v227
  v_pk_mul_f32 v[220:221], v[112:113], v[112:113]
  v_pk_mul_f32 v[222:223], v[114:115], v[114:115]
  v_pk_fma_f32 v[220:221], v[116:117], v[116:117], v[220:221]
  v_pk_fma_f32 v[222:223], v[118:119], v[118:119], v[222:223]
  v_pk_fma_f32 v[220:221], v[120:121], v[120:121], v[220:221]
  v_pk_fma_f32 v[222:223], v[122:123], v[122:123], v[222:223]
  v_pk_fma_f32 v[220:221], v[124:125], v[124:125], v[220:221]
  v_pk_fma_f32 v[222:223], v[126:127], v[126:127], v[222:223]
  v_pk_fma_f32 v[220:221], v[128:129], v[128:129], v[220:221]
  v_pk_fma_f32 v[222:223], v[130:131], v[130:131], v[222:223]
  v_pk_fma_f32 v[220:221], v[132:133], v[132:133], v[220:221]
  v_pk_fma_f32 v[222:223], v[134:135], v[134:135], v[222:223]
  v_pk_fma_f32 v[220:221], v[136:137], v[136:137], v[220:221]
  v_pk_fma_f32 v[222:223], v[138:139], v[138:139], v[222:223]
  v_pk_fma_f32 v[220:221], v[140:141], v[140:141], v[220:221]
  v_pk_fma_f32 v[222:223], v[142:143], v[142:143], v[222:223]
  v_pk_add_f32 v[220:221], v[220:221], v[222:223]
  v_add_f32 v220, v220, v221
  v_lshlrev_b32 v4, 4, v0
  s_mov_b32 s1, 262144
  buffer_load_dwordx4 v[144:147], v4, s[52:55], s1 offen sc1
  s_mov_b32 s1, 274432
  buffer_load_dwordx4 v[148:151], v4, s[52:55], s1 offen sc1
  s_mov_b32 s1, 286720
  buffer_load_dwordx4 v[152:155], v4, s[52:55], s1 offen sc1
  s_mov_b32 s1, 299008
  buffer_load_dwordx4 v[156:159], v4, s[52:55], s1 offen sc1
  v_add_f32_dpp v216, v216, v216 row_ror:8 row_mask:0xf bank_mask:0xf
  s_add_u32 m0, s73, 98304
  s_add_u32 s76, s11, 2048
  buffer_load_dwordx4 v244, s[32:35], s76 offen offset:0  lds
  v_add_f32_dpp v220, v220, v220 row_ror:8 row_mask:0xf bank_mask:0xf
  v_add_f32_dpp v216, v216, v216 row_ror:4 row_mask:0xf bank_mask:0xf
  s_nop 0
  v_add_f32_dpp v220, v220, v220 row_ror:4 row_mask:0xf bank_mask:0xf
  v_add_f32_dpp v216, v216, v216 row_ror:2 row_mask:0xf bank_mask:0xf
  s_nop 0
  v_add_f32_dpp v220, v220, v220 row_ror:2 row_mask:0xf bank_mask:0xf
  v_add_f32_dpp v216, v216, v216 row_ror:1 row_mask:0xf bank_mask:0xf
  s_nop 0
  v_add_f32_dpp v220, v220, v220 row_ror:1 row_mask:0xf bank_mask:0xf
  v_fma_f32 v226, v216, s9, v228
  v_fma_f32 v227, v220, s9, v228
  v_rsq_f32 v226, v226
  v_rsq_f32 v227, v227
  s_nop 0
  v_pk_mul_f32 v[80:81], v[80:81], v[226:227] op_sel:[0,0] op_sel_hi:[1,0]
  buffer_load_dwordx4 v245, s[32:35], s76 offen offset:1024  lds
  v_pk_mul_f32 v[82:83], v[82:83], v[226:227] op_sel:[0,0] op_sel_hi:[1,0]
  v_pk_mul_f32 v[84:85], v[84:85], v[226:227] op_sel:[0,0] op_sel_hi:[1,0]
  v_pk_mul_f32 v[86:87], v[86:87], v[226:227] op_sel:[0,0] op_sel_hi:[1,0]
  v_pk_mul_f32 v[88:89], v[88:89], v[226:227] op_sel:[0,0] op_sel_hi:[1,0]
  v_pk_mul_f32 v[90:91], v[90:91], v[226:227] op_sel:[0,0] op_sel_hi:[1,0]
  v_pk_mul_f32 v[92:93], v[92:93], v[226:227] op_sel:[0,0] op_sel_hi:[1,0]
  v_pk_mul_f32 v[94:95], v[94:95], v[226:227] op_sel:[0,0] op_sel_hi:[1,0]
  v_pk_mul_f32 v[96:97], v[96:97], v[226:227] op_sel:[0,0] op_sel_hi:[1,0]
  v_pk_mul_f32 v[98:99], v[98:99], v[226:227] op_sel:[0,0] op_sel_hi:[1,0]
  v_pk_mul_f32 v[100:101], v[100:101], v[226:227] op_sel:[0,0] op_sel_hi:[1,0]
  v_pk_mul_f32 v[102:103], v[102:103], v[226:227] op_sel:[0,0] op_sel_hi:[1,0]
  v_pk_mul_f32 v[104:105], v[104:105], v[226:227] op_sel:[0,0] op_sel_hi:[1,0]
  v_pk_mul_f32 v[106:107], v[106:107], v[226:227] op_sel:[0,0] op_sel_hi:[1,0]
  v_pk_mul_f32 v[108:109], v[108:109], v[226:227] op_sel:[0,0] op_sel_hi:[1,0]
  buffer_load_dwordx4 v246, s[32:35], s76 offen offset:2048  lds
  v_pk_mul_f32 v[110:111], v[110:111], v[226:227] op_sel:[0,0] op_sel_hi:[1,0]
  v_pk_mul_f32 v[112:113], v[112:113], v[226:227] op_sel:[0,1] op_sel_hi:[1,1]
  v_pk_mul_f32 v[114:115], v[114:115], v[226:227] op_sel:[0,1] op_sel_hi:[1,1]
  v_pk_mul_f32 v[116:117], v[116:117], v[226:227] op_sel:[0,1] op_sel_hi:[1,1]
  v_pk_mul_f32 v[118:119], v[118:119], v[226:227] op_sel:[0,1] op_sel_hi:[1,1]
  v_pk_mul_f32 v[120:121], v[120:121], v[226:227] op_sel:[0,1] op_sel_hi:[1,1]
  v_pk_mul_f32 v[122:123], v[122:123], v[226:227] op_sel:[0,1] op_sel_hi:[1,1]
  v_pk_mul_f32 v[124:125], v[124:125], v[226:227] op_sel:[0,1] op_sel_hi:[1,1]
  v_pk_mul_f32 v[126:127], v[126:127], v[226:227] op_sel:[0,1] op_sel_hi:[1,1]
  v_pk_mul_f32 v[128:129], v[128:129], v[226:227] op_sel:[0,1] op_sel_hi:[1,1]
  v_pk_mul_f32 v[130:131], v[130:131], v[226:227] op_sel:[0,1] op_sel_hi:[1,1]
  v_pk_mul_f32 v[132:133], v[132:133], v[226:227] op_sel:[0,1] op_sel_hi:[1,1]
  v_pk_mul_f32 v[134:135], v[134:135], v[226:227] op_sel:[0,1] op_sel_hi:[1,1]
  v_pk_mul_f32 v[136:137], v[136:137], v[226:227] op_sel:[0,1] op_sel_hi:[1,1]
  buffer_load_dwordx4 v247, s[32:35], s76 offen offset:3072  lds
  s_add_u32 m0, s73, 114688
  s_add_u32 s76, s11, 395264
  v_pk_mul_f32 v[138:139], v[138:139], v[226:227] op_sel:[0,1] op_sel_hi:[1,1]
  v_pk_mul_f32 v[140:141], v[140:141], v[226:227] op_sel:[0,1] op_sel_hi:[1,1]
  v_pk_mul_f32 v[142:143], v[142:143], v[226:227] op_sel:[0,1] op_sel_hi:[1,1]
  buffer_load_dwordx4 v244, s[32:35], s76 offen offset:0  lds
  buffer_load_dwordx4 v245, s[32:35], s76 offen offset:1024  lds
  buffer_load_dwordx4 v246, s[32:35], s76 offen offset:2048  lds
  buffer_load_dwordx4 v247, s[32:35], s76 offen offset:3072  lds
  s_add_u32 m0, s73, 65536
  s_add_u32 s76, s11, 788480
  buffer_load_dwordx4 v244, s[32:35], s76 offen offset:0  lds
  buffer_load_dwordx4 v245, s[32:35], s76 offen offset:1024  lds
  s_waitcnt vmcnt(14)
  s_barrier
  ds_read_b64_tr_b16 a[0:1], v252 offset:0
L_pad1:
  s_cbranch_execz L_pad5
  ds_read_b64_tr_b16 a[2:3], v252 offset:256
  ds_read_b64_tr_b16 a[4:5], v252 offset:4096
  ds_read_b64_tr_b16 a[6:7], v252 offset:4352
  ds_read_b64_tr_b16 a[8:9], v252 offset:8192
  ds_read_b64_tr_b16 a[10:11], v252 offset:8448
  ds_read_b64_tr_b16 a[12:13], v252 offset:12288
  ds_read_b64_tr_b16 a[14:15], v252 offset:12544
  ds_read_b64_tr_b16 a[16:17], v252 offset:16384
  ds_read_b64_tr_b16 a[18:19], v252 offset:16640
  ds_read_b64_tr_b16 a[20:21], v252 offset:20480
  ds_read_b64_tr_b16 a[22:23], v252 offset:20736
  ds_read_b64_tr_b16 a[24:25], v252 offset:24576
  ds_read_b64_tr_b16 a[26:27], v252 offset:24832
  ds_read_b64_tr_b16 a[28:29], v252 offset:28672
  ds_read_b64_tr_b16 a[30:31], v252 offset:28928
  ds_read_b64_tr_b16 a[32:33], v252 offset:32768
  ds_read_b64_tr_b16 a[34:35], v252 offset:33024
  ds_read_b64_tr_b16 a[36:37], v252 offset:36864
  ds_read_b64_tr_b16 a[38:39], v252 offset:37120
  ds_read_b64_tr_b16 a[40:41], v252 offset:40960
  ds_read_b64_tr_b16 a[42:43], v252 offset:41216
  ds_read_b64_tr_b16 a[44:45], v252 offset:45056
  ds_read_b64_tr_b16 a[46:47], v252 offset:45312
  ds_read_b64_tr_b16 a[48:49], v252 offset:49152
  ds_read_b64_tr_b16 a[50:51], v252 offset:49408
  ds_read_b64_tr_b16 a[52:53], v252 offset:53248
  ds_read_b64_tr_b16 a[54:55], v252 offset:53504
  ds_read_b64_tr_b16 a[56:57], v252 offset:57344
  ds_read_b64_tr_b16 a[58:59], v252 offset:57600
  ds_read_b64_tr_b16 a[60:61], v252 offset:61440
  ds_read_b64_tr_b16 a[62:63], v252 offset:61696
  buffer_load_dwordx4 v246, s[32:35], s76 offen offset:2048  lds
  buffer_load_dwordx4 v247, s[32:35], s76 offen offset:3072  lds
  s_add_u32 m0, s73, 81920
  s_add_u32 s76, s11, 1181696
  s_bfe_u32 s4, s65, 0x80000
  s_bfe_u32 s5, s65, 0x80008
  s_bfe_u32 s6, s65, 0x80010
  s_bfe_u32 s7, s65, 0x80018
  s_mov_b32 s8, 0
  s_waitcnt vmcnt(12)
L_gchk_3:
  v_xor_b32 v144, s4, v144
  v_xor_b32 v145, s5, v145
  v_xor_b32 v146, s6, v146
  v_xor_b32 v147, s7, v147
  v_xor_b32 v148, s4, v148
  v_xor_b32 v149, s5, v149
  v_xor_b32 v150, s6, v150
  v_xor_b32 v151, s7, v151
  v_xor_b32 v152, s4, v152
  v_xor_b32 v153, s5, v153
  v_xor_b32 v154, s6, v154
  v_xor_b32 v155, s7, v155
  v_xor_b32 v156, s4, v156
  v_xor_b32 v157, s5, v157
  v_xor_b32 v158, s6, v158
  v_xor_b32 v159, s7, v159
  v_or3_b32 v3, v144, v145, v146
  v_or3_b32 v3, v3, v147, v148
  v_or3_b32 v3, v3, v149, v150
  v_or3_b32 v3, v3, v151, v152
  v_or3_b32 v3, v3, v153, v154
  v_or3_b32 v3, v3, v155, v156
  v_or3_b32 v3, v3, v157, v158
  v_or_b32 v3, v3, v159
  v_lshlrev_b32 v3, 24, v3
  v_cmp_ne_u32 vcc, 0, v3
  s_cbranch_vccnz L_gagain_4
L_gok_5:
  v_pk_add_f32 v[144:145], v[144:145], v[148:149]
  v_pk_add_f32 v[152:153], v[152:153], v[156:157]
  v_pk_add_f32 v[146:147], v[146:147], v[150:151]
  v_pk_add_f32 v[154:155], v[154:155], v[158:159]
  v_pk_add_f32 v[144:145], v[144:145], v[152:153]
  v_pk_add_f32 v[146:147], v[146:147], v[154:155]
  v_cvt_pk_bf16_f32 v144, v144, v145
  v_cvt_pk_bf16_f32 v145, v146, v147
  s_cmp_ge_u32 s60, 2
  s_cselect_b32 s3, 1.0, 0
  v_lshlrev_b32 v148, 16, v144
  v_and_b32 v149, s68, v144
  v_lshlrev_b32 v150, 16, v145
  v_and_b32 v151, s68, v145
  v_add_f32 v148, s3, v148
  v_add_f32 v149, s3, v149
  v_add_f32 v150, s3, v150
  v_add_f32 v151, s3, v151
  v_cvt_pk_bf16_f32 v144, v148, v149
  v_cvt_pk_bf16_f32 v145, v150, v151
  v_lshlrev_b32 v148, 16, v144
  v_and_b32 v149, s68, v144
  v_lshlrev_b32 v150, 16, v145
  v_and_b32 v151, s68, v145
  ds_write_b128 v232, v[148:151]
  buffer_load_dwordx4 v244, s[32:35], s76 offen offset:0  lds
  buffer_load_dwordx4 v245, s[32:35], s76 offen offset:1024  lds
  s_waitcnt lgkmcnt(0)
  s_barrier
  ds_read_b128 v[144:147], v233 offset:0
  ds_read_b128 v[148:151], v233 offset:256
  ds_read_b128 v[176:179], v233 offset:2048
  ds_read_b128 v[180:183], v233 offset:2304
  ds_read_b128 v[152:155], v233 offset:512
  ds_read_b128 v[156:159], v233 offset:768
  ds_read_b128 v[184:187], v233 offset:2560
  ds_read_b128 v[188:191], v233 offset:2816
  v_lshrrev_b32 v254, 4, v1
  v_and_b32 v3, 15, v1
  v_xor_b32 v3, v3, v254
  v_lshlrev_b32 v3, 4, v3
  v_lshl_add_u32 v224, v254, 8, v3
  v_xor_b32 v225, 64, v224
  v_add_u32 v226, 65536, v252
  v_add_u32 v227, 131072, v252
  v_min_u32 v228, 1728, v253
  v_min_u32 v229, 448, v253
  v_lshrrev_b32 v3, 4, v0
  v_min_u32 v3, 9, v3
  v_lshlrev_b32 v3, 6, v3
  s_waitcnt lgkmcnt(4)
  v_pk_fma_f32 v[16:17], v[16:17], v[176:177], v[144:145]
  v_pk_fma_f32 v[18:19], v[18:19], v[178:179], v[146:147]
  v_pk_fma_f32 v[20:21], v[20:21], v[180:181], v[148:149]
  v_pk_fma_f32 v[22:23], v[22:23], v[182:183], v[150:151]
  v_cvt_pk_bf16_f32 v16, v16, v17
  v_cvt_pk_bf16_f32 v17, v18, v19
  v_cvt_pk_bf16_f32 v18, v20, v21
  v_cvt_pk_bf16_f32 v19, v22, v23
  ds_read_b128 v[160:163], v233 offset:1024
  ds_read_b128 v[164:167], v233 offset:1280
  ds_read_b128 v[192:195], v233 offset:3072
  ds_read_b128 v[196:199], v233 offset:3328
  ds_write_b128 v248, v[16:19] offset:0
  buffer_load_dwordx4 v246, s[32:35], s76 offen offset:2048  lds
  v_pk_fma_f32 v[48:49], v[48:49], v[176:177], v[144:145]
  v_pk_fma_f32 v[50:51], v[50:51], v[178:179], v[146:147]
  v_pk_fma_f32 v[52:53], v[52:53], v[180:181], v[148:149]
  v_pk_fma_f32 v[54:55], v[54:55], v[182:183], v[150:151]
  v_cvt_pk_bf16_f32 v48, v48, v49
  v_cvt_pk_bf16_f32 v49, v50, v51
  v_cvt_pk_bf16_f32 v50, v52, v53
  v_cvt_pk_bf16_f32 v51, v54, v55
  ds_write_b128 v249, v[48:51] offset:0
  buffer_load_dwordx4 v247, s[32:35], s76 offen offset:3072  lds
  s_lshl2_add_u32 s1, s2, s60
  s_mul_i32 s1, s1, 512
  v_pk_fma_f32 v[80:81], v[80:81], v[176:177], v[144:145]
  v_pk_fma_f32 v[82:83], v[82:83], v[178:179], v[146:147]
  v_pk_fma_f32 v[84:85], v[84:85], v[180:181], v[148:149]
  v_pk_fma_f32 v[86:87], v[86:87], v[182:183], v[150:151]
  v_cvt_pk_bf16_f32 v80, v80, v81
  v_cvt_pk_bf16_f32 v81, v82, v83
  v_cvt_pk_bf16_f32 v82, v84, v85
  v_cvt_pk_bf16_f32 v83, v86, v87
  ds_write_b128 v250, v[80:83] offset:0
  buffer_load_dword v255, v229, s[36:39], s1 offen
  s_lshl2_add_u32 s1, s2, s60
  s_mul_i32 s1, s1, 1792
  v_pk_fma_f32 v[112:113], v[112:113], v[176:177], v[144:145]
  v_pk_fma_f32 v[114:115], v[114:115], v[178:179], v[146:147]
  v_pk_fma_f32 v[116:117], v[116:117], v[180:181], v[148:149]
  v_pk_fma_f32 v[118:119], v[118:119], v[182:183], v[150:151]
  v_cvt_pk_bf16_f32 v112, v112, v113
  v_cvt_pk_bf16_f32 v113, v114, v115
  v_cvt_pk_bf16_f32 v114, v116, v117
  v_cvt_pk_bf16_f32 v115, v118, v119
  ds_write_b128 v251, v[112:115] offset:0
  buffer_load_dword v255, v228, s[40:43], s1 offen
  s_waitcnt lgkmcnt(8)
  v_pk_fma_f32 v[24:25], v[24:25], v[184:185], v[152:153]
  v_pk_fma_f32 v[26:27], v[26:27], v[186:187], v[154:155]
  v_pk_fma_f32 v[28:29], v[28:29], v[188:189], v[156:157]
  v_pk_fma_f32 v[30:31], v[30:31], v[190:191], v[158:159]
  v_cvt_pk_bf16_f32 v24, v24, v25
  v_cvt_pk_bf16_f32 v25, v26, v27
  v_cvt_pk_bf16_f32 v26, v28, v29
  v_cvt_pk_bf16_f32 v27, v30, v31
  ds_read_b128 v[168:171], v233 offset:1536
  ds_read_b128 v[172:175], v233 offset:1792
  ds_read_b128 v[200:203], v233 offset:3584
  ds_read_b128 v[204:207], v233 offset:3840
  ds_write_b128 v248, v[24:27] offset:16384
  buffer_load_dword v255, v3, s[52:55], s18 offen sc1
  s_mov_b32 s1, 0
  v_pk_fma_f32 v[56:57], v[56:57], v[184:185], v[152:153]
  v_pk_fma_f32 v[58:59], v[58:59], v[186:187], v[154:155]
  v_pk_fma_f32 v[60:61], v[60:61], v[188:189], v[156:157]
  v_pk_fma_f32 v[62:63], v[62:63], v[190:191], v[158:159]
  v_cvt_pk_bf16_f32 v56, v56, v57
  v_cvt_pk_bf16_f32 v57, v58, v59
  v_cvt_pk_bf16_f32 v58, v60, v61
  v_cvt_pk_bf16_f32 v59, v62, v63
  ds_write_b128 v249, v[56:59] offset:16384
  buffer_load_dwordx4 v[236:239], v234, s[48:51], s1 offen offset:2048
  s_add_u32 s1, s1, 98304
  v_pk_fma_f32 v[88:89], v[88:89], v[184:185], v[152:153]
  v_pk_fma_f32 v[90:91], v[90:91], v[186:187], v[154:155]
  v_pk_fma_f32 v[92:93], v[92:93], v[188:189], v[156:157]
  v_pk_fma_f32 v[94:95], v[94:95], v[190:191], v[158:159]
  v_cvt_pk_bf16_f32 v88, v88, v89
  v_cvt_pk_bf16_f32 v89, v90, v91
  v_cvt_pk_bf16_f32 v90, v92, v93
  v_cvt_pk_bf16_f32 v91, v94, v95
  ds_write_b128 v250, v[88:91] offset:16384
  buffer_load_dwordx4 v[240:243], v234, s[48:51], s1 offen offset:2048
  v_pk_fma_f32 v[120:121], v[120:121], v[184:185], v[152:153]
  v_pk_fma_f32 v[122:123], v[122:123], v[186:187], v[154:155]
  v_pk_fma_f32 v[124:125], v[124:125], v[188:189], v[156:157]
  v_pk_fma_f32 v[126:127], v[126:127], v[190:191], v[158:159]
  v_cvt_pk_bf16_f32 v120, v120, v121
  v_cvt_pk_bf16_f32 v121, v122, v123
  v_cvt_pk_bf16_f32 v122, v124, v125
  v_cvt_pk_bf16_f32 v123, v126, v127
  ds_write_b128 v251, v[120:123] offset:16384
  global_load_ushort v230, v235, s[16:17] offset:0
  s_waitcnt lgkmcnt(12)
  v_pk_fma_f32 v[32:33], v[32:33], v[192:193], v[160:161]
  v_pk_fma_f32 v[34:35], v[34:35], v[194:195], v[162:163]
  v_pk_fma_f32 v[36:37], v[36:37], v[196:197], v[164:165]
  v_pk_fma_f32 v[38:39], v[38:39], v[198:199], v[166:167]
  v_cvt_pk_bf16_f32 v32, v32, v33
  v_cvt_pk_bf16_f32 v33, v34, v35
  v_cvt_pk_bf16_f32 v34, v36, v37
  v_cvt_pk_bf16_f32 v35, v38, v39
  ds_write_b128 v248, v[32:35] offset:32768
  global_load_ushort v231, v235, s[16:17] offset:32
  v_pk_fma_f32 v[64:65], v[64:65], v[192:193], v[160:161]
  v_pk_fma_f32 v[66:67], v[66:67], v[194:195], v[162:163]
  v_pk_fma_f32 v[68:69], v[68:69], v[196:197], v[164:165]
  v_pk_fma_f32 v[70:71], v[70:71], v[198:199], v[166:167]
  v_cvt_pk_bf16_f32 v64, v64, v65
  v_cvt_pk_bf16_f32 v65, v66, v67
  v_cvt_pk_bf16_f32 v66, v68, v69
  v_cvt_pk_bf16_f32 v67, v70, v71
  ds_write_b128 v249, v[64:67] offset:32768
  v_pk_fma_f32 v[96:97], v[96:97], v[192:193], v[160:161]
  v_pk_fma_f32 v[98:99], v[98:99], v[194:195], v[162:163]
  v_pk_fma_f32 v[100:101], v[100:101], v[196:197], v[164:165]
  v_pk_fma_f32 v[102:103], v[102:103], v[198:199], v[166:167]
  v_cvt_pk_bf16_f32 v96, v96, v97
  v_cvt_pk_bf16_f32 v97, v98, v99
  v_cvt_pk_bf16_f32 v98, v100, v101
  v_cvt_pk_bf16_f32 v99, v102, v103
  ds_write_b128 v250, v[96:99] offset:32768
  v_pk_fma_f32 v[128:129], v[128:129], v[192:193], v[160:161]
  v_pk_fma_f32 v[130:131], v[130:131], v[194:195], v[162:163]
  v_pk_fma_f32 v[132:133], v[132:133], v[196:197], v[164:165]
  v_pk_fma_f32 v[134:135], v[134:135], v[198:199], v[166:167]
  v_cvt_pk_bf16_f32 v128, v128, v129
  v_cvt_pk_bf16_f32 v129, v130, v131
  v_cvt_pk_bf16_f32 v130, v132, v133
  v_cvt_pk_bf16_f32 v131, v134, v135
  ds_write_b128 v251, v[128:131] offset:32768
  s_waitcnt lgkmcnt(8)
  v_pk_fma_f32 v[40:41], v[40:41], v[200:201], v[168:169]
  v_pk_fma_f32 v[42:43], v[42:43], v[202:203], v[170:171]
  v_pk_fma_f32 v[44:45], v[44:45], v[204:205], v[172:173]
  v_pk_fma_f32 v[46:47], v[46:47], v[206:207], v[174:175]
  v_cvt_pk_bf16_f32 v40, v40, v41
  v_cvt_pk_bf16_f32 v41, v42, v43
  v_cvt_pk_bf16_f32 v42, v44, v45
  v_cvt_pk_bf16_f32 v43, v46, v47
  ds_write_b128 v248, v[40:43] offset:49152
  v_pk_fma_f32 v[72:73], v[72:73], v[200:201], v[168:169]
  v_pk_fma_f32 v[74:75], v[74:75], v[202:203], v[170:171]
  v_pk_fma_f32 v[76:77], v[76:77], v[204:205], v[172:173]
  v_pk_fma_f32 v[78:79], v[78:79], v[206:207], v[174:175]
  v_cvt_pk_bf16_f32 v72, v72, v73
  v_cvt_pk_bf16_f32 v73, v74, v75
  v_cvt_pk_bf16_f32 v74, v76, v77
  v_cvt_pk_bf16_f32 v75, v78, v79
  ds_write_b128 v249, v[72:75] offset:49152
  v_pk_fma_f32 v[104:105], v[104:105], v[200:201], v[168:169]
  v_pk_fma_f32 v[106:107], v[106:107], v[202:203], v[170:171]
  v_pk_fma_f32 v[108:109], v[108:109], v[204:205], v[172:173]
  v_pk_fma_f32 v[110:111], v[110:111], v[206:207], v[174:175]
  v_cvt_pk_bf16_f32 v104, v104, v105
  v_cvt_pk_bf16_f32 v105, v106, v107
  v_cvt_pk_bf16_f32 v106, v108, v109
  v_cvt_pk_bf16_f32 v107, v110, v111
  ds_write_b128 v250, v[104:107] offset:49152
  v_pk_fma_f32 v[136:137], v[136:137], v[200:201], v[168:169]
  v_pk_fma_f32 v[138:139], v[138:139], v[202:203], v[170:171]
  v_pk_fma_f32 v[140:141], v[140:141], v[204:205], v[172:173]
  v_pk_fma_f32 v[142:143], v[142:143], v[206:207], v[174:175]
  v_cvt_pk_bf16_f32 v136, v136, v137
  v_cvt_pk_bf16_f32 v137, v138, v139
  v_cvt_pk_bf16_f32 v138, v140, v141
  v_cvt_pk_bf16_f32 v139, v142, v143
  ds_write_b128 v251, v[136:139] offset:49152
  s_waitcnt vmcnt(15) lgkmcnt(0)
  s_barrier
  ds_read_b128 v[80:83], v224 offset:0
  ds_read_b64_tr_b16 v[64:65], v226 offset:32768
  ds_read_b64_tr_b16 v[66:67], v226 offset:33024
  ds_read_b128 v[84:87], v224 offset:1024
  ds_read_b128 v[88:91], v224 offset:2048
  ds_read_b128 v[92:95], v224 offset:3072
  ds_read_b128 v[96:99], v225 offset:4096
  ds_read_b64_tr_b16 v[68:69], v226 offset:36864
  ds_read_b64_tr_b16 v[70:71], v226 offset:37120
  ds_read_b128 v[100:103], v225 offset:5120
  ds_read_b128 v[104:107], v225 offset:6144
  ds_read_b128 v[108:111], v225 offset:7168
  s_waitcnt lgkmcnt(6)
  v_mfma_f32_16x16x32_bf16 v[144:147], a[0:3], v[80:83], 0
  ds_read_b128 v[112:115], v224 offset:8192
  s_add_u32 m0, s73, 131072
  v_mfma_f32_16x16x32_bf16 v[160:163], v[80:83], v[64:67], 0
  ds_read_b64_tr_b16 v[72:73], v226 offset:40960
  s_add_u32 s76, s11, 0
  v_mfma_f32_16x16x32_bf16 v[148:151], a[0:3], v[84:87], 0
  ds_read_b64_tr_b16 v[74:75], v226 offset:41216
  s_cmp_lg_u32 s60, 3
  s_cbranch_scc1 L_cw_6
  s_andn2_b32 s3, s65, 15
  s_or_b32 s3, s3, s66
  v_mov_b32 v16, s3
  s_lshl_b32 s3, s64, 7
  s_lshl2_add_u32 s3, s63, s3
  s_add_u32 s3, s3, 4096
  s_mov_b64 exec, 1
  buffer_store_dword v16, off, s[52:55], s3 sc1
  s_mov_b64 exec, -1
L_cw_6:
  v_mfma_f32_16x16x32_bf16 v[164:167], v[84:87], v[64:67], 0
  ds_read_b128 v[116:119], v224 offset:9216
  v_mov_b64 v[52:53], v[208:209]
  v_mfma_f32_16x16x32_bf16 v[152:155], a[0:3], v[88:91], 0
  ds_read_b128 v[120:123], v224 offset:10240
  v_mov_b64 v[54:55], v[210:211]
  v_mfma_f32_16x16x32_bf16 v[168:171], v[88:91], v[64:67], 0
  ds_read_b128 v[124:127], v224 offset:11264
  v_mov_b64 v[56:57], v[212:213]
  v_mfma_f32_16x16x32_bf16 v[156:159], a[0:3], v[92:95], 0
  buffer_load_dwordx4 v244, s[32:35], s76 offen offset:0  lds
  v_mfma_f32_16x16x32_bf16 v[172:175], v[92:95], v[64:67], 0
  v_mov_b64 v[58:59], v[214:215]
  s_waitcnt lgkmcnt(6)
  v_mfma_f32_16x16x32_bf16 v[144:147], a[4:7], v[96:99], v[144:147]
  ds_read_b128 v[128:131], v225 offset:12288
  v_add_u32 v51, s77, v2
  v_mfma_f32_16x16x32_bf16 v[160:163], v[96:99], v[68:71], v[160:163]
  ds_read_b64_tr_b16 v[76:77], v226 offset:45056
  v_and_b32 v60, 31, v1
  v_mfma_f32_16x16x32_bf16 v[148:151], a[4:7], v[100:103], v[148:151]
  ds_read_b64_tr_b16 v[78:79], v226 offset:45312
  v_lshrrev_b32 v61, 5, v1
  v_mfma_f32_16x16x32_bf16 v[164:167], v[100:103], v[68:71], v[164:167]
  ds_read_b128 v[132:135], v225 offset:13312
  v_lshlrev_b32 v61, 2, v61
  v_mfma_f32_16x16x32_bf16 v[152:155], a[4:7], v[104:107], v[152:155]
  ds_read_b128 v[136:139], v225 offset:14336
  v_sub_u32 v60, v60, v61
  v_mfma_f32_16x16x32_bf16 v[168:171], v[104:107], v[68:71], v[168:171]
  ds_read_b128 v[140:143], v225 offset:15360
  v_mov_b32 v61, 0xf149f2ca
  v_mfma_f32_16x16x32_bf16 v[156:159], a[4:7], v[108:111], v[156:159]
  buffer_load_dwordx4 v245, s[32:35], s76 offen offset:1024  lds
  v_mfma_f32_16x16x32_bf16 v[172:175], v[108:111], v[68:71], v[172:175]
  v_mov_b32 v62, 0
  s_waitcnt lgkmcnt(6)
  v_mfma_f32_16x16x32_bf16 v[144:147], a[8:11], v[112:115], v[144:147]
  ds_read_b128 a[64:67], v224 offset:16384
  v_and_b32 v233, 11, v1
  v_mfma_f32_16x16x32_bf16 v[160:163], v[112:115], v[72:75], v[160:163]
  ds_read_b64_tr_b16 v[64:65], v226 offset:49152
  v_cmp_eq_u32 vcc, 0, v233
  v_mfma_f32_16x16x32_bf16 v[148:151], a[8:11], v[116:119], v[148:151]
  ds_read_b64_tr_b16 v[66:67], v226 offset:49408
  v_mov_b32 v233, s10
  v_mfma_f32_16x16x32_bf16 v[164:167], v[116:119], v[72:75], v[164:167]
  ds_read_b128 a[68:71], v224 offset:17408
  v_cndmask_b32 v232, v62, v233, vcc
  v_mfma_f32_16x16x32_bf16 v[152:155], a[8:11], v[120:123], v[152:155]
  ds_read_b128 a[72:75], v224 offset:18432
  v_cmp_le_i32 vcc, 0, v60
  v_mfma_f32_16x16x32_bf16 v[168:171], v[120:123], v[72:75], v[168:171]
  ds_read_b128 a[76:79], v224 offset:19456
  v_mov_b32 v36, v232
  v_mfma_f32_16x16x32_bf16 v[156:159], a[8:11], v[124:127], v[156:159]
  buffer_load_dwordx4 v246, s[32:35], s76 offen offset:2048  lds
  v_mfma_f32_16x16x32_bf16 v[172:175], v[124:127], v[72:75], v[172:175]
  v_cndmask_b32 v192, v61, v62, vcc
  s_waitcnt lgkmcnt(6)
  v_mfma_f32_16x16x32_bf16 v[144:147], a[12:15], v[128:131], v[144:147]
  ds_read_b128 a[80:83], v225 offset:20480
  v_cndmask_b32 v208, v62, v61, vcc
  v_mfma_f32_16x16x32_bf16 v[160:163], v[128:131], v[76:79], v[160:163]
  ds_read_b64_tr_b16 v[68:69], v226 offset:53248
  v_cmp_le_i32 vcc, 1, v60
  v_mfma_f32_16x16x32_bf16 v[148:151], a[12:15], v[132:135], v[148:151]
  ds_read_b64_tr_b16 v[70:71], v226 offset:53504
  v_mov_b32 v37, v232
  v_mfma_f32_16x16x32_bf16 v[164:167], v[132:135], v[76:79], v[164:167]
  ds_read_b128 a[84:87], v225 offset:21504
  v_cndmask_b32 v193, v61, v62, vcc
  v_mfma_f32_16x16x32_bf16 v[152:155], a[12:15], v[136:139], v[152:155]
  ds_read_b128 a[88:91], v225 offset:22528
  v_cndmask_b32 v209, v62, v61, vcc
  v_mfma_f32_16x16x32_bf16 v[168:171], v[136:139], v[76:79], v[168:171]
  ds_read_b128 a[92:95], v225 offset:23552
  v_cmp_le_i32 vcc, 2, v60
  v_mfma_f32_16x16x32_bf16 v[156:159], a[12:15], v[140:143], v[156:159]
  buffer_load_dwordx4 v247, s[32:35], s76 offen offset:3072  lds
  v_mfma_f32_16x16x32_bf16 v[172:175], v[140:143], v[76:79], v[172:175]
  s_add_u32 m0, s73, 147456
  s_waitcnt lgkmcnt(6)
  v_mfma_f32_16x16x32_bf16 v[144:147], a[16:19], a[64:67], v[144:147]
  ds_read_b128 a[96:99], v224 offset:24576
  s_add_u32 s76, s11, 393216
  v_mfma_f32_16x16x32_bf16 v[160:163], a[64:67], v[64:67], v[160:163]
  ds_read_b64_tr_b16 v[72:73], v226 offset:57344
  v_mov_b32 v38, v232
  v_mfma_f32_16x16x32_bf16 v[148:151], a[16:19], a[68:71], v[148:151]
  ds_read_b64_tr_b16 v[74:75], v226 offset:57600
  v_cndmask_b32 v194, v61, v62, vcc
  v_mfma_f32_16x16x32_bf16 v[164:167], a[68:71], v[64:67], v[164:167]
  ds_read_b128 a[100:103], v224 offset:25600
  v_cndmask_b32 v210, v62, v61, vcc
  v_mfma_f32_16x16x32_bf16 v[152:155], a[16:19], a[72:75], v[152:155]
  ds_read_b128 a[104:107], v224 offset:26624
  v_cmp_le_i32 vcc, 3, v60
  v_mfma_f32_16x16x32_bf16 v[168:171], a[72:75], v[64:67], v[168:171]
  ds_read_b128 a[108:111], v224 offset:27648
  v_mov_b32 v39, v232
  v_mfma_f32_16x16x32_bf16 v[156:159], a[16:19], a[76:79], v[156:159]
  buffer_load_dwordx4 v244, s[32:35], s76 offen offset:0  lds
  v_mfma_f32_16x16x32_bf16 v[172:175], a[76:79], v[64:67], v[172:175]
  v_cndmask_b32 v195, v61, v62, vcc
  s_waitcnt vmcnt(12) lgkmcnt(6)
  s_barrier
  v_mfma_f32_16x16x32_bf16 v[144:147], a[20:23], a[80:83], v[144:147]
  ds_read_b128 a[112:115], v225 offset:28672
  v_cndmask_b32 v211, v62, v61, vcc
  v_mfma_f32_16x16x32_bf16 v[160:163], a[80:83], v[68:71], v[160:163]
  ds_read_b64_tr_b16 v[76:77], v226 offset:61440
  v_cmp_le_i32 vcc, 8, v60
  v_mfma_f32_16x16x32_bf16 v[148:151], a[20:23], a[84:87], v[148:151]
  ds_read_b64_tr_b16 v[78:79], v226 offset:61696
  v_mov_b32 v44, v232
  v_mfma_f32_16x16x32_bf16 v[164:167], a[84:87], v[68:71], v[164:167]
  ds_read_b128 a[116:119], v225 offset:29696
  v_cndmask_b32 v196, v61, v62, vcc
  v_mfma_f32_16x16x32_bf16 v[152:155], a[20:23], a[88:91], v[152:155]
  ds_read_b128 a[120:123], v225 offset:30720
  v_cndmask_b32 v212, v62, v61, vcc
  v_mfma_f32_16x16x32_bf16 v[168:171], a[88:91], v[68:71], v[168:171]
  ds_read_b128 a[124:127], v225 offset:31744
  v_cmp_le_i32 vcc, 9, v60
  v_mfma_f32_16x16x32_bf16 v[156:159], a[20:23], a[92:95], v[156:159]
  buffer_load_dwordx4 v245, s[32:35], s76 offen offset:1024  lds
  v_mfma_f32_16x16x32_bf16 v[172:175], a[92:95], v[68:71], v[172:175]
  v_mov_b32 v45, v232
  s_waitcnt lgkmcnt(6)
  v_mfma_f32_16x16x32_bf16 v[144:147], a[24:27], a[96:99], v[144:147]
  ds_read_b128 a[128:131], v224 offset:32768
  v_cndmask_b32 v197, v61, v62, vcc
  v_mfma_f32_16x16x32_bf16 v[160:163], a[96:99], v[72:75], v[160:163]
  ds_read_b64_tr_b16 v[64:65], v226 offset:0
  v_cndmask_b32 v213, v62, v61, vcc
  v_mfma_f32_16x16x32_bf16 v[148:151], a[24:27], a[100:103], v[148:151]
  ds_read_b64_tr_b16 v[66:67], v226 offset:256
  v_cmp_le_i32 vcc, 10, v60
  v_mfma_f32_16x16x32_bf16 v[164:167], a[100:103], v[72:75], v[164:167]
  ds_read_b128 a[132:135], v224 offset:33792
  v_mov_b32 v46, v232
  v_mfma_f32_16x16x32_bf16 v[152:155], a[24:27], a[104:107], v[152:155]
  ds_read_b128 a[136:139], v224 offset:34816
  v_cndmask_b32 v198, v61, v62, vcc
  v_mfma_f32_16x16x32_bf16 v[168:171], a[104:107], v[72:75], v[168:171]
  ds_read_b128 a[140:143], v224 offset:35840
  v_cndmask_b32 v214, v62, v61, vcc
  v_mfma_f32_16x16x32_bf16 v[156:159], a[24:27], a[108:111], v[156:159]
  buffer_load_dwordx4 v246, s[32:35], s76 offen offset:2048  lds
  v_mfma_f32_16x16x32_bf16 v[172:175], a[108:111], v[72:75], v[172:175]
  v_cmp_le_i32 vcc, 11, v60
  s_waitcnt lgkmcnt(6)
  v_mfma_f32_16x16x32_bf16 v[144:147], a[28:31], a[112:115], v[144:147]
  ds_read_b128 a[144:147], v225 offset:36864
  v_mov_b32 v47, v232
  v_mfma_f32_16x16x32_bf16 v[160:163], a[112:115], v[76:79], v[160:163]
  ds_read_b64_tr_b16 v[68:69], v226 offset:4096
  v_cndmask_b32 v199, v61, v62, vcc
  v_mfma_f32_16x16x32_bf16 v[148:151], a[28:31], a[116:119], v[148:151]
  ds_read_b64_tr_b16 v[70:71], v226 offset:4352
  v_cndmask_b32 v215, v62, v61, vcc
  v_mfma_f32_16x16x32_bf16 v[164:167], a[116:119], v[76:79], v[164:167]
  ds_read_b128 a[148:151], v225 offset:37888
  v_cmp_le_i32 vcc, 16, v60
  v_mfma_f32_16x16x32_bf16 v[152:155], a[28:31], a[120:123], v[152:155]
  ds_read_b128 a[152:155], v225 offset:38912
  v_cndmask_b32 v200, v61, v62, vcc
  v_mfma_f32_16x16x32_bf16 v[168:171], a[120:123], v[76:79], v[168:171]
  ds_read_b128 a[156:159], v225 offset:39936
  v_cndmask_b32 v216, v62, v61, vcc
  v_mfma_f32_16x16x32_bf16 v[156:159], a[28:31], a[124:127], v[156:159]
  buffer_load_dwordx4 v247, s[32:35], s76 offen offset:3072  lds
  v_mfma_f32_16x16x32_bf16 v[172:175], a[124:127], v[76:79], v[172:175]
  s_add_u32 m0, s73, 0
  s_waitcnt lgkmcnt(6)
  s_barrier
  v_mfma_f32_16x16x32_bf16 v[144:147], a[32:35], a[128:131], v[144:147]
  ds_read_b128 a[160:163], v224 offset:40960
  s_lshl3_add_u32 s76, s73, 0
  v_mfma_f32_16x16x32_bf16 v[160:163], a[128:131], v[64:67], v[160:163]
  ds_read_b64_tr_b16 v[72:73], v226 offset:8192
  v_cmp_le_i32 vcc, 17, v60
  v_mfma_f32_16x16x32_bf16 v[148:151], a[32:35], a[132:135], v[148:151]
  ds_read_b64_tr_b16 v[74:75], v226 offset:8448
  v_cndmask_b32 v201, v61, v62, vcc
  v_mfma_f32_16x16x32_bf16 v[164:167], a[132:135], v[64:67], v[164:167]
  ds_read_b128 a[164:167], v224 offset:41984
  v_cndmask_b32 v217, v62, v61, vcc
  v_mfma_f32_16x16x32_bf16 v[152:155], a[32:35], a[136:139], v[152:155]
  ds_read_b128 a[168:171], v224 offset:43008
  v_cmp_le_i32 vcc, 18, v60
  v_mfma_f32_16x16x32_bf16 v[168:171], a[136:139], v[64:67], v[168:171]
  ds_read_b128 a[172:175], v224 offset:44032
  v_cndmask_b32 v202, v61, v62, vcc
  v_mfma_f32_16x16x32_bf16 v[156:159], a[32:35], a[140:143], v[156:159]
  buffer_load_dwordx4 v9, s[36:39], s76 offen offset:0  lds
  v_mfma_f32_16x16x32_bf16 v[172:175], a[140:143], v[64:67], v[172:175]
  buffer_load_dwordx4 v10, s[36:39], s76 offen offset:1024  lds
  s_waitcnt lgkmcnt(6)
  v_mfma_f32_16x16x32_bf16 v[144:147], a[36:39], a[144:147], v[144:147]
  ds_read_b128 a[176:179], v225 offset:45056
  s_add_u32 s76, s76, 14336
  v_mfma_f32_16x16x32_bf16 v[160:163], a[144:147], v[68:71], v[160:163]
  ds_read_b64_tr_b16 v[76:77], v226 offset:12288
  v_cndmask_b32 v218, v62, v61, vcc
  v_mfma_f32_16x16x32_bf16 v[148:151], a[36:39], a[148:151], v[148:151]
  ds_read_b64_tr_b16 v[78:79], v226 offset:12544
  v_cmp_le_i32 vcc, 19, v60
  v_mfma_f32_16x16x32_bf16 v[164:167], a[148:151], v[68:71], v[164:167]
  ds_read_b128 a[180:183], v225 offset:46080
  v_cndmask_b32 v203, v61, v62, vcc
  v_mfma_f32_16x16x32_bf16 v[152:155], a[36:39], a[152:155], v[152:155]
  ds_read_b128 a[184:187], v225 offset:47104
  v_cndmask_b32 v219, v62, v61, vcc
  v_mfma_f32_16x16x32_bf16 v[168:171], a[152:155], v[68:71], v[168:171]
  ds_read_b128 a[188:191], v225 offset:48128
  v_cmp_le_i32 vcc, 24, v60
  v_mfma_f32_16x16x32_bf16 v[156:159], a[36:39], a[156:159], v[156:159]
  buffer_load_dwordx4 v9, s[36:39], s76 offen offset:2048  lds
  v_mfma_f32_16x16x32_bf16 v[172:175], a[156:159], v[68:71], v[172:175]
  buffer_load_dwordx4 v10, s[36:39], s76 offen offset:3072  lds
  s_waitcnt lgkmcnt(6)
  v_mfma_f32_16x16x32_bf16 v[144:147], a[40:43], a[160:163], v[144:147]
  ds_read_b128 a[192:195], v224 offset:49152
  s_add_u32 m0, s73, 98304
  v_mfma_f32_16x16x32_bf16 v[160:163], a[160:163], v[72:75], v[160:163]
  ds_read_b64_tr_b16 v[64:65], v226 offset:16384
  s_add_u32 s76, s11, 786432
  v_mfma_f32_16x16x32_bf16 v[148:151], a[40:43], a[164:167], v[148:151]
  ds_read_b64_tr_b16 v[66:67], v226 offset:16640
  v_cndmask_b32 v204, v61, v62, vcc
  v_mfma_f32_16x16x32_bf16 v[164:167], a[164:167], v[72:75], v[164:167]
  ds_read_b128 a[196:199], v224 offset:50176
  v_cndmask_b32 v220, v62, v61, vcc
  v_mfma_f32_16x16x32_bf16 v[152:155], a[40:43], a[168:171], v[152:155]
  ds_read_b128 a[200:203], v224 offset:51200
  v_cmp_le_i32 vcc, 25, v60
  v_mfma_f32_16x16x32_bf16 v[168:171], a[168:171], v[72:75], v[168:171]
  ds_read_b128 a[204:207], v224 offset:52224
  v_cndmask_b32 v205, v61, v62, vcc
  v_mfma_f32_16x16x32_bf16 v[156:159], a[40:43], a[172:175], v[156:159]
  buffer_load_dwordx4 v244, s[32:35], s76 offen offset:0  lds
  v_mfma_f32_16x16x32_bf16 v[172:175], a[172:175], v[72:75], v[172:175]
  buffer_load_dwordx4 v245, s[32:35], s76 offen offset:1024  lds
  s_waitcnt lgkmcnt(6)
  v_mfma_f32_16x16x32_bf16 v[144:147], a[44:47], a[176:179], v[144:147]
  ds_read_b128 a[208:211], v225 offset:53248
  v_cndmask_b32 v221, v62, v61, vcc
  v_mfma_f32_16x16x32_bf16 v[160:163], a[176:179], v[76:79], v[160:163]
  ds_read_b64_tr_b16 v[68:69], v226 offset:20480
  v_cmp_le_i32 vcc, 26, v60
  v_mfma_f32_16x16x32_bf16 v[148:151], a[44:47], a[180:183], v[148:151]
  ds_read_b64_tr_b16 v[70:71], v226 offset:20736
  v_cndmask_b32 v206, v61, v62, vcc
  v_mfma_f32_16x16x32_bf16 v[164:167], a[180:183], v[76:79], v[164:167]
  ds_read_b128 a[212:215], v225 offset:54272
  v_cndmask_b32 v222, v62, v61, vcc
  v_mfma_f32_16x16x32_bf16 v[152:155], a[44:47], a[184:187], v[152:155]
  ds_read_b128 a[216:219], v225 offset:55296
  v_cmp_le_i32 vcc, 27, v60
  v_mfma_f32_16x16x32_bf16 v[168:171], a[184:187], v[76:79], v[168:171]
  ds_read_b128 a[220:223], v225 offset:56320
L_pad2:
  s_cbranch_execz L_pad6
  v_cndmask_b32 v207, v61, v62, vcc
  v_mfma_f32_16x16x32_bf16 v[156:159], a[44:47], a[188:191], v[156:159]
  buffer_load_dwordx4 v246, s[32:35], s76 offen offset:2048  lds
  v_mfma_f32_16x16x32_bf16 v[172:175], a[188:191], v[76:79], v[172:175]
  buffer_load_dwordx4 v247, s[32:35], s76 offen offset:3072  lds
  s_waitcnt lgkmcnt(6)
  v_mfma_f32_16x16x32_bf16 v[144:147], a[48:51], a[192:195], v[144:147]
  ds_read_b128 a[224:227], v224 offset:57344
  s_add_u32 m0, s73, 114688
  v_mfma_f32_16x16x32_bf16 v[160:163], a[192:195], v[64:67], v[160:163]
  ds_read_b64_tr_b16 v[72:73], v226 offset:24576
  s_add_u32 s76, s11, 1179648
  v_mfma_f32_16x16x32_bf16 v[148:151], a[48:51], a[196:199], v[148:151]
  ds_read_b64_tr_b16 v[74:75], v226 offset:24832
  v_cndmask_b32 v223, v62, v61, vcc
  v_mfma_f32_16x16x32_bf16 v[164:167], a[196:199], v[64:67], v[164:167]
  ds_read_b128 a[228:231], v224 offset:58368
  v_bfe_u32 v48, v1, 4, 1
  v_mfma_f32_16x16x32_bf16 v[152:155], a[48:51], a[200:203], v[152:155]
  ds_read_b128 a[232:235], v224 offset:59392
  v_lshl_add_u32 v48, v48, 9, v15
  v_mfma_f32_16x16x32_bf16 v[168:171], a[200:203], v[64:67], v[168:171]
  ds_read_b128 a[236:239], v224 offset:60416
  v_and_b32 v50, 15, v1
  v_mfma_f32_16x16x32_bf16 v[156:159], a[48:51], a[204:207], v[156:159]
  buffer_load_dwordx4 v244, s[32:35], s76 offen offset:0  lds
  v_mfma_f32_16x16x32_bf16 v[172:175], a[204:207], v[64:67], v[172:175]
  v_lshlrev_b32 v50, 2, v50
  s_waitcnt lgkmcnt(6)
  v_mfma_f32_16x16x32_bf16 v[144:147], a[52:55], a[208:211], v[144:147]
  ds_read_b128 a[240:243], v225 offset:61440
  v_mfma_f32_16x16x32_bf16 v[160:163], a[208:211], v[68:71], v[160:163]
  ds_read_b64_tr_b16 v[76:77], v226 offset:28672
  v_mfma_f32_16x16x32_bf16 v[148:151], a[52:55], a[212:215], v[148:151]
  ds_read_b64_tr_b16 v[78:79], v226 offset:28928
  v_mfma_f32_16x16x32_bf16 v[164:167], a[212:215], v[68:71], v[164:167]
  ds_read_b128 a[244:247], v225 offset:62464
  v_mfma_f32_16x16x32_bf16 v[152:155], a[52:55], a[216:219], v[152:155]
  ds_read_b128 a[248:251], v225 offset:63488
  v_mfma_f32_16x16x32_bf16 v[168:171], a[216:219], v[68:71], v[168:171]
  ds_read_b128 a[252:255], v225 offset:64512
  v_mfma_f32_16x16x32_bf16 v[156:159], a[52:55], a[220:223], v[156:159]
  buffer_load_dwordx4 v245, s[32:35], s76 offen offset:1024  lds
  v_mfma_f32_16x16x32_bf16 v[172:175], a[220:223], v[68:71], v[172:175]
  s_waitcnt lgkmcnt(6)
  v_mfma_f32_16x16x32_bf16 v[144:147], a[56:59], a[224:227], v[144:147]
  v_mfma_f32_16x16x32_bf16 v[160:163], a[224:227], v[72:75], v[160:163]
  v_mfma_f32_16x16x32_bf16 v[148:151], a[56:59], a[228:231], v[148:151]
  v_mfma_f32_16x16x32_bf16 v[164:167], a[228:231], v[72:75], v[164:167]
  buffer_load_dwordx4 v246, s[32:35], s76 offen offset:2048  lds
  v_mfma_f32_16x16x32_bf16 v[152:155], a[56:59], a[232:235], v[152:155]
  v_mfma_f32_16x16x32_bf16 v[168:171], a[232:235], v[72:75], v[168:171]
  v_mfma_f32_16x16x32_bf16 v[156:159], a[56:59], a[236:239], v[156:159]
  v_mfma_f32_16x16x32_bf16 v[172:175], a[236:239], v[72:75], v[172:175]
  s_waitcnt lgkmcnt(0)
  v_mfma_f32_16x16x32_bf16 v[144:147], a[60:63], a[240:243], v[144:147]
  buffer_load_dwordx4 v247, s[32:35], s76 offen offset:3072  lds
  v_mfma_f32_16x16x32_bf16 v[160:163], a[240:243], v[76:79], v[160:163]
  v_mfma_f32_16x16x32_bf16 v[148:151], a[60:63], a[244:247], v[148:151]
  v_mfma_f32_16x16x32_bf16 v[164:167], a[244:247], v[76:79], v[164:167]
  v_mfma_f32_16x16x32_bf16 v[152:155], a[60:63], a[248:251], v[152:155]
  v_mfma_f32_16x16x32_bf16 v[168:171], a[248:251], v[76:79], v[168:171]
  v_mfma_f32_16x16x32_bf16 v[156:159], a[60:63], a[252:255], v[156:159]
  v_mfma_f32_16x16x32_bf16 v[172:175], a[252:255], v[76:79], v[172:175]
  v_cvt_pk_bf16_f32 v24, v144, v145
  v_cvt_pk_bf16_f32 v25, v146, v147
  s_nop 0
  v_cvt_pk_bf16_f32 v26, v148, v149
  v_cvt_pk_bf16_f32 v27, v150, v151
  v_cvt_pk_bf16_f32 v28, v152, v153
  v_cvt_pk_bf16_f32 v29, v154, v155
  v_cvt_pk_bf16_f32 v30, v156, v157
  v_cvt_pk_bf16_f32 v31, v158, v159
  v_permlane16_swap_b32 v24, v26
  v_permlane16_swap_b32 v25, v27
  buffer_store_dwordx4 v[24:27], v2, s[52:55], s12 offen offset:0 sc1
  v_permlane16_swap_b32 v28, v30
  v_permlane16_swap_b32 v29, v31
  v_cvt_pk_bf16_f32 v32, v160, v161
  v_cvt_pk_bf16_f32 v33, v162, v163
  v_cvt_pk_bf16_f32 v34, v164, v165
  v_cvt_pk_bf16_f32 v35, v166, v167
  v_cvt_pk_bf16_f32 v40, v168, v169
  v_cvt_pk_bf16_f32 v41, v170, v171
  v_cvt_pk_bf16_f32 v42, v172, v173
  v_cvt_pk_bf16_f32 v43, v174, v175
  buffer_store_dwordx4 v[28:31], v2, s[52:55], s12 offen offset:2048 sc1
  v_permlane16_swap_b32 v32, v34
  v_permlane16_swap_b32 v33, v35
  v_permlane16_swap_b32 v40, v42
  v_permlane16_swap_b32 v41, v43
  v_permlane32_swap_b32 v32, v34
  v_permlane32_swap_b32 v33, v35
  buffer_store_dwordx4 v[32:35], v48, s[52:55], s12 offen offset:1024 sc1
  v_permlane32_swap_b32 v40, v42
  v_permlane32_swap_b32 v41, v43
  s_waitcnt vmcnt(15)
  s_barrier
  ds_read_b64_tr_b16 v[64:65], v227 offset:0
  ds_read_b64_tr_b16 v[66:67], v227 offset:256
  ds_read_b64_tr_b16 v[68:69], v227 offset:4096
  ds_read_b64_tr_b16 v[70:71], v227 offset:4352
  ds_read_b64_tr_b16 v[72:73], v227 offset:8192
  ds_read_b64_tr_b16 v[74:75], v227 offset:8448
  buffer_store_dwordx4 v[40:43], v48, s[52:55], s12 offen offset:3072 sc1
  s_waitcnt lgkmcnt(2)
  v_mfma_f32_16x16x32_bf16 v[176:179], v[64:67], v[80:83], 0
  s_lshl_b32 s1, s64, 7
  s_add_u32 s1, s1, 4096
  v_mfma_f32_16x16x32_bf16 v[176:179], v[68:71], v[96:99], v[176:179]
  ds_read_b64_tr_b16 v[76:77], v227 offset:12288
  v_mfma_f32_16x16x32_bf16 v[180:183], v[64:67], v[84:87], 0
  ds_read_b64_tr_b16 v[78:79], v227 offset:12544
  v_mfma_f32_16x16x32_bf16 v[180:183], v[68:71], v[100:103], v[180:183]
  v_permlane16_swap_b32 v32, v36
  v_mfma_f32_16x16x32_bf16 v[184:187], v[64:67], v[88:91], 0
  v_permlane16_swap_b32 v33, v37
  v_mfma_f32_16x16x32_bf16 v[184:187], v[68:71], v[104:107], v[184:187]
  ds_read_b64_tr_b16 v[144:145], v227 offset:16384
  v_mfma_f32_16x16x32_bf16 v[188:191], v[64:67], v[92:95], 0
  ds_read_b64_tr_b16 v[146:147], v227 offset:16640
  v_mfma_f32_16x16x32_bf16 v[188:191], v[68:71], v[108:111], v[188:191]
  s_waitcnt lgkmcnt(2)
  v_mfma_f32_16x16x32_bf16 v[176:179], v[72:75], v[112:115], v[176:179]
  v_permlane16_swap_b32 v34, v38
  v_mfma_f32_16x16x32_bf16 v[176:179], v[76:79], v[128:131], v[176:179]
  ds_read_b64_tr_b16 v[148:149], v227 offset:20480
  v_mfma_f32_16x16x32_bf16 v[180:183], v[72:75], v[116:119], v[180:183]
  ds_read_b64_tr_b16 v[150:151], v227 offset:20736
  v_mfma_f32_16x16x32_bf16 v[180:183], v[76:79], v[132:135], v[180:183]
  v_permlane16_swap_b32 v35, v39
  v_mfma_f32_16x16x32_bf16 v[184:187], v[72:75], v[120:123], v[184:187]
  v_permlane16_swap_b32 v40, v44
  v_mfma_f32_16x16x32_bf16 v[184:187], v[76:79], v[136:139], v[184:187]
  ds_read_b64_tr_b16 v[64:65], v227 offset:24576
  v_mfma_f32_16x16x32_bf16 v[188:191], v[72:75], v[124:127], v[188:191]
  ds_read_b64_tr_b16 v[66:67], v227 offset:24832
  v_mfma_f32_16x16x32_bf16 v[188:191], v[76:79], v[140:143], v[188:191]
  s_waitcnt vmcnt(4) lgkmcnt(2)
  s_barrier
  v_mfma_f32_16x16x32_bf16 v[176:179], v[144:147], a[64:67], v[176:179]
  v_permlane16_swap_b32 v41, v45
  v_mfma_f32_16x16x32_bf16 v[176:179], v[148:151], a[80:83], v[176:179]
  ds_read_b64_tr_b16 v[68:69], v227 offset:28672
  s_cmp_ge_u32 s61, 4
  s_cselect_b32 s6, s10, 0
  v_mfma_f32_16x16x32_bf16 v[180:183], v[144:147], a[68:71], v[180:183]
  ds_read_b64_tr_b16 v[70:71], v227 offset:28928
  v_and_b32 v80, s6, v232
  v_mfma_f32_16x16x32_bf16 v[180:183], v[148:151], a[84:87], v[180:183]
  v_permlane16_swap_b32 v42, v46
  v_mfma_f32_16x16x32_bf16 v[184:187], v[144:147], a[72:75], v[184:187]
  buffer_load_dword v63, v50, s[52:55], s1 offen sc1
  v_mfma_f32_16x16x32_bf16 v[184:187], v[148:151], a[88:91], v[184:187]
  ds_read_b64_tr_b16 v[72:73], v226 offset:32768
  s_add_u32 m0, s73, 16384
  v_mfma_f32_16x16x32_bf16 v[188:191], v[144:147], a[76:79], v[188:191]
  ds_read_b64_tr_b16 v[74:75], v226 offset:33024
  s_lshl3_add_u32 s76, s73, 131072
  v_mfma_f32_16x16x32_bf16 v[188:191], v[148:151], a[92:95], v[188:191]
  v_and_b32 v81, s6, v232
  s_waitcnt lgkmcnt(2)
  v_mfma_f32_16x16x32_bf16 v[176:179], v[64:67], a[96:99], v[176:179]
  buffer_load_dwordx4 v9, s[36:39], s76 offen offset:0  lds
  v_mfma_f32_16x16x32_bf16 v[176:179], v[68:71], a[112:115], v[176:179]
  ds_read_b64_tr_b16 v[76:77], v226 offset:36864
  v_mov_b64 v[82:83], v[80:81]
  v_mfma_f32_16x16x32_bf16 v[180:183], v[64:67], a[100:103], v[180:183]
  ds_read_b64_tr_b16 v[78:79], v226 offset:37120
  v_mov_b64 v[84:85], v[80:81]
  v_mfma_f32_16x16x32_bf16 v[180:183], v[68:71], a[116:119], v[180:183]
  v_permlane16_swap_b32 v43, v47
  v_mfma_f32_16x16x32_bf16 v[184:187], v[64:67], a[104:107], v[184:187]
  buffer_load_dwordx4 v10, s[36:39], s76 offen offset:1024  lds
  v_mfma_f32_16x16x32_bf16 v[184:187], v[68:71], a[120:123], v[184:187]
  ds_read_b64_tr_b16 v[144:145], v226 offset:40960
  s_add_u32 s76, s76, 14336
  v_mfma_f32_16x16x32_bf16 v[188:191], v[64:67], a[108:111], v[188:191]
  ds_read_b64_tr_b16 v[146:147], v226 offset:41216
  v_bfe_u32 v16, v1, 4, 1
  v_mfma_f32_16x16x32_bf16 v[188:191], v[68:71], a[124:127], v[188:191]
  v_lshrrev_b32 v19, 5, v1
  s_waitcnt lgkmcnt(2)
  v_mfma_f32_16x16x32_bf16 v[176:179], v[72:75], a[128:131], v[176:179]
  buffer_load_dwordx4 v9, s[36:39], s76 offen offset:2048  lds
  v_mfma_f32_16x16x32_bf16 v[176:179], v[76:79], a[144:147], v[176:179]
  ds_read_b64_tr_b16 v[148:149], v226 offset:45056
  v_lshl_add_u32 v48, v16, 8, v13
  v_mfma_f32_16x16x32_bf16 v[180:183], v[72:75], a[132:135], v[180:183]
  ds_read_b64_tr_b16 v[150:151], v226 offset:45312
  v_mul_u32_u24 v19, 0x700, v19
  v_mfma_f32_16x16x32_bf16 v[180:183], v[76:79], a[148:151], v[180:183]
  v_add_u32 v48, v19, v48
  v_xor_b32 v49, 32, v48
  v_mfma_f32_16x16x32_bf16 v[184:187], v[72:75], a[136:139], v[184:187]
  buffer_load_dwordx4 v10, s[36:39], s76 offen offset:3072  lds
  v_mfma_f32_16x16x32_bf16 v[184:187], v[76:79], a[152:155], v[184:187]
  ds_read_b64_tr_b16 v[64:65], v226 offset:49152
  s_add_u32 m0, s73, 32768
  v_mfma_f32_16x16x32_bf16 v[188:191], v[72:75], a[140:143], v[188:191]
  ds_read_b64_tr_b16 v[66:67], v226 offset:49408
  s_lshl3_add_u32 s76, s73, 262144
  v_mfma_f32_16x16x32_bf16 v[188:191], v[76:79], a[156:159], v[188:191]
  v_mov_b64 v[86:87], v[80:81]
  s_waitcnt lgkmcnt(2)
  v_mfma_f32_16x16x32_bf16 v[176:179], v[144:147], a[160:163], v[176:179]
  buffer_load_dwordx4 v9, s[36:39], s76 offen offset:0  lds
  v_mfma_f32_16x16x32_bf16 v[176:179], v[148:151], a[176:179], v[176:179]
  ds_read_b64_tr_b16 v[68:69], v226 offset:53248
  v_mov_b64 v[88:89], v[80:81]
  v_mfma_f32_16x16x32_bf16 v[180:183], v[144:147], a[164:167], v[180:183]
  ds_read_b64_tr_b16 v[70:71], v226 offset:53504
  v_mov_b64 v[90:91], v[80:81]
  v_mfma_f32_16x16x32_bf16 v[180:183], v[148:151], a[180:183], v[180:183]
  v_mov_b64 v[92:93], v[80:81]
  v_mov_b64 v[94:95], v[80:81]
  v_mfma_f32_16x16x32_bf16 v[184:187], v[144:147], a[168:171], v[184:187]
  buffer_load_dwordx4 v10, s[36:39], s76 offen offset:1024  lds
  v_mfma_f32_16x16x32_bf16 v[184:187], v[148:151], a[184:187], v[184:187]
  ds_read_b64_tr_b16 v[72:73], v226 offset:57344
  s_add_u32 s76, s76, 14336
  v_mfma_f32_16x16x32_bf16 v[188:191], v[144:147], a[172:175], v[188:191]
  ds_read_b64_tr_b16 v[74:75], v226 offset:57600
  s_cmp_ge_u32 s61, 3
  s_cselect_b32 s6, s10, 0
  v_mfma_f32_16x16x32_bf16 v[188:191], v[148:151], a[188:191], v[188:191]
  v_and_b32 v96, s6, v232
  s_waitcnt lgkmcnt(2)
  v_mfma_f32_16x16x32_bf16 v[176:179], v[64:67], a[192:195], v[176:179]
  buffer_load_dwordx4 v9, s[36:39], s76 offen offset:2048  lds
  v_mfma_f32_16x16x32_bf16 v[176:179], v[68:71], a[208:211], v[176:179]
  ds_read_b64_tr_b16 v[76:77], v226 offset:61440
  v_and_b32 v97, s6, v232
  v_mfma_f32_16x16x32_bf16 v[180:183], v[64:67], a[196:199], v[180:183]
  ds_read_b64_tr_b16 v[78:79], v226 offset:61696
  v_mov_b64 v[98:99], v[96:97]
  v_mfma_f32_16x16x32_bf16 v[180:183], v[68:71], a[212:215], v[180:183]
  v_mov_b64 v[100:101], v[96:97]
  v_mov_b64 v[102:103], v[96:97]
  v_mfma_f32_16x16x32_bf16 v[184:187], v[64:67], a[200:203], v[184:187]
  buffer_load_dwordx4 v10, s[36:39], s76 offen offset:3072  lds
  v_mfma_f32_16x16x32_bf16 v[184:187], v[68:71], a[216:219], v[184:187]
  s_add_u32 m0, s73, 49152
  s_lshl3_add_u32 s76, s73, 393216
  v_mfma_f32_16x16x32_bf16 v[188:191], v[64:67], a[204:207], v[188:191]
  v_mov_b64 v[104:105], v[96:97]
  v_mov_b64 v[106:107], v[96:97]
  v_mfma_f32_16x16x32_bf16 v[188:191], v[68:71], a[220:223], v[188:191]
  v_mov_b64 v[108:109], v[96:97]
  s_waitcnt lgkmcnt(0)
  v_mfma_f32_16x16x32_bf16 v[176:179], v[72:75], a[224:227], v[176:179]
  buffer_load_dwordx4 v9, s[36:39], s76 offen offset:0  lds
  v_mfma_f32_16x16x32_bf16 v[176:179], v[76:79], a[240:243], v[176:179]
  v_mov_b64 v[110:111], v[96:97]
  s_cmp_ge_u32 s61, 2
  s_cselect_b32 s6, s10, 0
  v_mfma_f32_16x16x32_bf16 v[180:183], v[72:75], a[228:231], v[180:183]
  v_and_b32 v112, s6, v232
  v_and_b32 v113, s6, v232
  v_mfma_f32_16x16x32_bf16 v[180:183], v[76:79], a[244:247], v[180:183]
  v_mov_b64 v[114:115], v[112:113]
  v_mov_b64 v[116:117], v[112:113]
  v_mfma_f32_16x16x32_bf16 v[184:187], v[72:75], a[232:235], v[184:187]
  buffer_load_dwordx4 v10, s[36:39], s76 offen offset:1024  lds
  v_mfma_f32_16x16x32_bf16 v[184:187], v[76:79], a[248:251], v[184:187]
  s_add_u32 s76, s76, 14336
  v_mov_b64 v[118:119], v[112:113]
  v_mfma_f32_16x16x32_bf16 v[188:191], v[72:75], a[236:239], v[188:191]
  v_mov_b64 v[120:121], v[112:113]
  v_mov_b64 v[122:123], v[112:113]
  v_mfma_f32_16x16x32_bf16 v[188:191], v[76:79], a[252:255], v[188:191]
  v_mov_b64 v[124:125], v[112:113]
  v_mov_b32 v3, s65
  s_waitcnt vmcnt(11)
  s_mov_b64 exec, 0xffff
  buffer_store_dword v3, v50, s[52:55], s13 offen sc1
  s_mov_b64 exec, -1
  v_mov_b64 v[126:127], v[112:113]
  s_cmp_ge_u32 s61, 1
  s_cselect_b32 s6, s10, 0
  v_and_b32 v128, s6, v232
  v_and_b32 v129, s6, v232
  v_mov_b64 v[130:131], v[128:129]
  v_mov_b64 v[132:133], v[128:129]
  v_mov_b64 v[134:135], v[128:129]
  v_mov_b64 v[136:137], v[128:129]
  v_mov_b64 v[138:139], v[128:129]
  v_mov_b64 v[140:141], v[128:129]
  v_mov_b64 v[142:143], v[128:129]
  buffer_load_dwordx4 v9, s[36:39], s76 offen offset:2048  lds
  buffer_load_dwordx4 v10, s[36:39], s76 offen offset:3072  lds
  s_mov_b32 s4, 0x3eb8aa3b
  s_mov_b32 s5, 0x3eb8aa3b
  v_pk_mul_f32 v[176:177], v[176:177], s[4:5]
  v_pk_mul_f32 v[178:179], v[178:179], s[4:5]
  v_pk_mul_f32 v[180:181], v[180:181], s[4:5]
  v_pk_mul_f32 v[182:183], v[182:183], s[4:5]
  v_cvt_pk_bf16_f32 v16, v176, v177
  v_cvt_pk_bf16_f32 v17, v178, v179
  v_cvt_pk_bf16_f32 v18, v180, v181
  v_cvt_pk_bf16_f32 v19, v182, v183
  v_pk_mul_f32 v[184:185], v[184:185], s[4:5]
  v_pk_mul_f32 v[186:187], v[186:187], s[4:5]
  v_pk_mul_f32 v[188:189], v[188:189], s[4:5]
  v_pk_mul_f32 v[190:191], v[190:191], s[4:5]
  v_permlane16_swap_b32 v16, v18
  v_permlane16_swap_b32 v17, v19
  v_cvt_pk_bf16_f32 v20, v184, v185
  v_cvt_pk_bf16_f32 v21, v186, v187
  v_cvt_pk_bf16_f32 v22, v188, v189
  v_cvt_pk_bf16_f32 v23, v190, v191
  s_cmp_lt_u32 s63, 14
  s_cselect_b32 s42, 1835008, 0
  s_add_u32 m0, s73, 65536
  s_mul_i32 s76, s73, 28
  s_add_u32 s76, s76, 128
  buffer_load_dwordx4 v5, s[40:43], s76 offen offset:0  lds
  v_permlane16_swap_b32 v20, v22
  v_permlane16_swap_b32 v21, v23
  s_mov_b64 s[32:33], s[24:25]
  s_andn2_b32 s3, s65, 15
  s_or_b32 s3, s3, s66
  s_mov_b32 s67, 1
  s_waitcnt vmcnt(14)
  v_cmp_ne_u32 vcc, s3, v63
  s_cbranch_vccnz L_hagain_7
L_hok_9:
  buffer_load_dwordx4 v6, s[40:43], s76 offen offset:1024  lds
  v_lshlrev_b32 v230, 16, v230
  v_lshlrev_b32 v231, 16, v231
  v_mul_f32 v232, 0xbfb8aa3b, v230
  v_mul_f32 v233, 0xbfb8aa3b, v231
  v_exp_f32 v232, v232
  v_exp_f32 v233, v233
  v_lshlrev_b32 v160, 16, v236
  v_and_b32 v161, s68, v236
  v_add_f32 v232, 1.0, v232
  v_add_f32 v233, 1.0, v233
  v_rcp_f32 v232, v232
  v_rcp_f32 v233, v233
  v_lshlrev_b32 v162, 16, v237
  v_and_b32 v163, s68, v237
  v_mul_f32 v230, v230, v232
  v_mul_f32 v231, v231, v233
  v_cvt_pk_bf16_f32 v230, v230, v230
  v_cvt_pk_bf16_f32 v231, v231, v231
  v_and_b32 v230, s68, v230
  v_and_b32 v231, s68, v231
  v_lshlrev_b32 v164, 16, v238
  v_and_b32 v165, s68, v238
  v_lshlrev_b32 v166, 16, v239
  v_and_b32 v167, s68, v239
  v_pk_mul_f32 v[176:177], v[160:161], v[230:231] op_sel_hi:[1,0]
  v_pk_mul_f32 v[178:179], v[162:163], v[230:231] op_sel_hi:[1,0]
  v_pk_mul_f32 v[180:181], v[164:165], v[230:231] op_sel_hi:[1,0]
  v_pk_mul_f32 v[182:183], v[166:167], v[230:231] op_sel_hi:[1,0]
  v_lshlrev_b32 v160, 16, v240
  v_and_b32 v161, s68, v240
  v_lshlrev_b32 v162, 16, v241
  v_and_b32 v163, s68, v241
  v_lshlrev_b32 v164, 16, v242
  v_and_b32 v165, s68, v242
  v_lshlrev_b32 v166, 16, v243
  v_and_b32 v167, s68, v243
  v_pk_fma_f32 v[176:177], v[160:161], v[230:231], v[176:177] op_sel:[0,1,0] op_sel_hi:[1,1,1]
  v_pk_fma_f32 v[178:179], v[162:163], v[230:231], v[178:179] op_sel:[0,1,0] op_sel_hi:[1,1,1]
  v_pk_fma_f32 v[180:181], v[164:165], v[230:231], v[180:181] op_sel:[0,1,0] op_sel_hi:[1,1,1]
  v_pk_fma_f32 v[182:183], v[166:167], v[230:231], v[182:183] op_sel:[0,1,0] op_sel_hi:[1,1,1]
  v_and_b32 v3, 3, v1
  v_lshlrev_b32 v3, 5, v3
  v_permlane32_swap_b32 v176, v180
  v_permlane32_swap_b32 v177, v181
  v_permlane32_swap_b32 v178, v182
  v_permlane32_swap_b32 v179, v183
  v_pk_add_f32 v[176:177], v[176:177], v[180:181]
  v_pk_add_f32 v[178:179], v[178:179], v[182:183]
  v_lshrrev_b32 v4, 4, v1
  v_lshl_add_u32 v3, v4, 3, v3
  v_permlane16_swap_b32 v176, v178
  v_permlane16_swap_b32 v177, v179
  v_pk_add_f32 v[176:177], v[176:177], v[178:179]
  s_lshl_b32 s5, s60, 7
  s_add_u32 s5, s5, 139264
  v_add_f32_dpp v176, v176, v176 row_ror:8 row_mask:0xf bank_mask:0xf
  v_add_f32_dpp v177, v177, v177 row_ror:8 row_mask:0xf bank_mask:0xf
  v_add_u32 v3, s5, v3
  v_add_f32_dpp v176, v176, v176 row_ror:4 row_mask:0xf bank_mask:0xf
  v_add_f32_dpp v177, v177, v177 row_ror:4 row_mask:0xf bank_mask:0xf
  v_and_b32 v4, 7, v1
  ds_write_b64 v3, v[176:177]
  v_lshlrev_b32 v4, 4, v4
  v_add_u32 v3, 139264, v4
  buffer_load_dwordx4 v7, s[40:43], s76 offen offset:2048  lds
  buffer_load_dwordx4 v8, s[40:43], s76 offen offset:3072  lds
  s_add_u32 m0, s73, 81920
  s_mul_i32 s76, s73, 28
  s_add_u32 s76, s76, 458880
  s_waitcnt vmcnt(13)
  s_waitcnt lgkmcnt(0)
  s_barrier
  s_cmp_lg_u32 s60, 0
  s_cbranch_scc1 L_cw_10
  ds_read_b128 v[160:163], v3 offset:0
  ds_read_b128 v[164:167], v3 offset:128
  ds_read_b128 v[168:171], v3 offset:256
  ds_read_b128 v[172:175], v3 offset:384
  s_bfe_u32 s5, s2, 0x20005
  s_mul_i32 s5, s5, 12288
  s_and_b32 s3, s62, 3
  s_lshl2_add_u32 s4, s64, s3
  s_lshl_b32 s4, s4, 7
  s_add_u32 s4, s4, s5
  s_add_u32 s4, s4, 266240
  v_mov_b32 v176, s65
  v_lshrrev_b32 v177, 8, v176
  v_lshrrev_b32 v178, 16, v176
  v_lshrrev_b32 v179, 24, v176
  s_movk_i32 s5, 0xff
  s_waitcnt lgkmcnt(0)
  v_pk_add_f32 v[160:161], v[160:161], v[164:165]
  v_pk_add_f32 v[168:169], v[168:169], v[172:173]
  v_pk_add_f32 v[162:163], v[162:163], v[166:167]
  v_pk_add_f32 v[170:171], v[170:171], v[174:175]
  v_pk_add_f32 v[160:161], v[160:161], v[168:169]
  v_pk_add_f32 v[162:163], v[162:163], v[170:171]
  v_bfi_b32 v176, s5, v176, v160
  v_bfi_b32 v177, s5, v177, v161
  v_bfi_b32 v178, s5, v178, v162
  v_bfi_b32 v179, s5, v179, v163
  s_mov_b64 exec, 255
  buffer_store_dwordx4 v[176:179], v4, s[52:55], s4 offen sc1
  s_mov_b64 exec, -1
  s_nop 1
L_cw_10:
  s_cmp_ge_u32 s61, 1
  s_cselect_b32 s3, 4096, 0
  s_sub_u32 s4, s13, s3
  s_cmp_ge_u32 s61, 2
  s_cselect_b32 s3, 8192, 0
  s_sub_u32 s5, s13, s3
  s_cmp_ge_u32 s61, 3
  s_cselect_b32 s3, 12288, 0
  s_sub_u32 s6, s13, s3
  s_cmp_ge_u32 s61, 4
  s_cselect_b32 s3, 16384, 0
  s_sub_u32 s7, s13, s3
  ds_write_b128 v51, v[52:55]
  ds_write_b128 v51, v[56:59] offset:1024
  s_lshl2_add_u32 s3, s2, s60
  s_cmp_eq_u32 s3, 3
  s_cbranch_scc1 L_ep_11
L_epb_12:
  s_load_dword s8, s[24:25], s4 glc
  s_load_dword s9, s[24:25], s5 glc
  s_load_dword s10, s[24:25], s6 glc
  s_load_dword s11, s[24:25], s7 glc
  ds_read_b64_tr_b16 a[0:1], v48 offset:0
  ds_read_b64_tr_b16 a[2:3], v48 offset:1024
  ds_read_b64_tr_b16 a[4:5], v49 offset:0
  ds_read_b64_tr_b16 a[6:7], v49 offset:1024
  ds_read_b64_tr_b16 a[8:9], v48 offset:512
  ds_read_b64_tr_b16 a[10:11], v48 offset:1536
  ds_read_b64_tr_b16 a[12:13], v49 offset:512
  ds_read_b64_tr_b16 a[14:15], v49 offset:1536
  buffer_load_dwordx4 v5, s[40:43], s76 offen offset:0  lds
  ds_read_b64_tr_b16 a[16:17], v48 offset:4096
  ds_read_b64_tr_b16 a[18:19], v48 offset:5120
  ds_read_b64_tr_b16 a[20:21], v49 offset:4096
  ds_read_b64_tr_b16 a[22:23], v49 offset:5120
  ds_read_b64_tr_b16 a[24:25], v48 offset:4608
  ds_read_b64_tr_b16 a[26:27], v48 offset:5632
  ds_read_b64_tr_b16 a[28:29], v49 offset:4608
  ds_read_b64_tr_b16 a[30:31], v49 offset:5632
  ds_read_b64_tr_b16 a[32:33], v48 offset:8192
  ds_read_b64_tr_b16 a[34:35], v48 offset:9216
  ds_read_b64_tr_b16 a[36:37], v49 offset:8192
  ds_read_b64_tr_b16 a[38:39], v49 offset:9216
  ds_read_b64_tr_b16 a[40:41], v48 offset:8704
  ds_read_b64_tr_b16 a[42:43], v48 offset:9728
  ds_read_b64_tr_b16 a[44:45], v49 offset:8704
  ds_read_b64_tr_b16 a[46:47], v49 offset:9728
  buffer_load_dwordx4 v6, s[40:43], s76 offen offset:1024  lds
  ds_read_b64_tr_b16 a[48:49], v48 offset:12288
  ds_read_b64_tr_b16 a[50:51], v48 offset:13312
  ds_read_b64_tr_b16 a[52:53], v49 offset:12288
  ds_read_b64_tr_b16 a[54:55], v49 offset:13312
  ds_read_b64_tr_b16 a[56:57], v48 offset:12800
  ds_read_b64_tr_b16 a[58:59], v48 offset:13824
  ds_read_b64_tr_b16 a[60:61], v49 offset:12800
  ds_read_b64_tr_b16 a[62:63], v49 offset:13824
  ds_read_b64_tr_b16 a[64:65], v48 offset:16384
  ds_read_b64_tr_b16 a[66:67], v48 offset:17408
  ds_read_b64_tr_b16 a[68:69], v49 offset:16384
  ds_read_b64_tr_b16 a[70:71], v49 offset:17408
  ds_read_b64_tr_b16 a[72:73], v48 offset:16896
  ds_read_b64_tr_b16 a[74:75], v48 offset:17920
  ds_read_b64_tr_b16 a[76:77], v49 offset:16896
  ds_read_b64_tr_b16 a[78:79], v49 offset:17920
  buffer_load_dwordx4 v7, s[40:43], s76 offen offset:2048  lds
  ds_read_b64_tr_b16 a[80:81], v48 offset:20480
  ds_read_b64_tr_b16 a[82:83], v48 offset:21504
  ds_read_b64_tr_b16 a[84:85], v49 offset:20480
  ds_read_b64_tr_b16 a[86:87], v49 offset:21504
  ds_read_b64_tr_b16 a[88:89], v48 offset:20992
  ds_read_b64_tr_b16 a[90:91], v48 offset:22016
  ds_read_b64_tr_b16 a[92:93], v49 offset:20992
  ds_read_b64_tr_b16 a[94:95], v49 offset:22016
  ds_read_b64_tr_b16 a[96:97], v48 offset:24576
  ds_read_b64_tr_b16 a[98:99], v48 offset:25600
  ds_read_b64_tr_b16 a[100:101], v49 offset:24576
  ds_read_b64_tr_b16 a[102:103], v49 offset:25600
  ds_read_b64_tr_b16 a[104:105], v48 offset:25088
  ds_read_b64_tr_b16 a[106:107], v48 offset:26112
  ds_read_b64_tr_b16 a[108:109], v49 offset:25088
  ds_read_b64_tr_b16 a[110:111], v49 offset:26112
  buffer_load_dwordx4 v8, s[40:43], s76 offen offset:3072  lds
  s_add_u32 m0, s73, 98304
  s_mul_i32 s76, s73, 28
  s_add_u32 s76, s76, 917632
  ds_read_b64_tr_b16 a[112:113], v48 offset:28672
  ds_read_b64_tr_b16 a[114:115], v48 offset:29696
  ds_read_b64_tr_b16 a[116:117], v49 offset:28672
  ds_read_b64_tr_b16 a[118:119], v49 offset:29696
  ds_read_b64_tr_b16 a[120:121], v48 offset:29184
  ds_read_b64_tr_b16 a[122:123], v48 offset:30208
  ds_read_b64_tr_b16 a[124:125], v49 offset:29184
  ds_read_b64_tr_b16 a[126:127], v49 offset:30208
  s_waitcnt vmcnt(8)
  s_barrier
  ds_read_b64_tr_b16 a[128:129], v48 offset:32768
  ds_read_b64_tr_b16 a[130:131], v48 offset:33792
  ds_read_b64_tr_b16 a[132:133], v49 offset:32768
  ds_read_b64_tr_b16 a[134:135], v49 offset:33792
  ds_read_b64_tr_b16 a[136:137], v48 offset:33280
  ds_read_b64_tr_b16 a[138:139], v48 offset:34304
  ds_read_b64_tr_b16 a[140:141], v49 offset:33280
  ds_read_b64_tr_b16 a[142:143], v49 offset:34304
  buffer_load_dwordx4 v5, s[40:43], s76 offen offset:0  lds
  ds_read_b64_tr_b16 a[144:145], v48 offset:36864
  ds_read_b64_tr_b16 a[146:147], v48 offset:37888
  ds_read_b64_tr_b16 a[148:149], v49 offset:36864
  ds_read_b64_tr_b16 a[150:151], v49 offset:37888
  ds_read_b64_tr_b16 a[152:153], v48 offset:37376
  ds_read_b64_tr_b16 a[154:155], v48 offset:38400
  ds_read_b64_tr_b16 a[156:157], v49 offset:37376
  ds_read_b64_tr_b16 a[158:159], v49 offset:38400
  ds_read_b64_tr_b16 a[160:161], v48 offset:40960
  ds_read_b64_tr_b16 a[162:163], v48 offset:41984
  ds_read_b64_tr_b16 a[164:165], v49 offset:40960
  ds_read_b64_tr_b16 a[166:167], v49 offset:41984
  ds_read_b64_tr_b16 a[168:169], v48 offset:41472
  ds_read_b64_tr_b16 a[170:171], v48 offset:42496
  ds_read_b64_tr_b16 a[172:173], v49 offset:41472
  ds_read_b64_tr_b16 a[174:175], v49 offset:42496
  buffer_load_dwordx4 v6, s[40:43], s76 offen offset:1024  lds
  s_mov_b32 s3, 0
L_kvp_15:
  s_waitcnt lgkmcnt(0)
  s_xor_b32 s8, s8, s65
  s_xor_b32 s9, s9, s65
  s_or_b32 s8, s8, s9
  s_xor_b32 s10, s10, s65
  s_or_b32 s8, s8, s10
  s_xor_b32 s11, s11, s65
  s_or_b32 s8, s8, s11
  s_cbranch_scc1 L_kva_16
L_kvd_17:
  s_mov_b32 s8, 0xffff
  s_mov_b32 s9, 0xffff
  s_cmp_ge_u32 s61, 1
  s_cselect_b32 s34, 0x1000000, 0
  s_sub_u32 s3, s12, 4096
  buffer_load_dwordx4 v[76:79], v2, s[32:35], s3 offen offset:2048 sc1
  buffer_load_dwordx4 v[72:75], v2, s[32:35], s3 offen offset:0 sc1
  s_mov_b64 exec, s[8:9]
  buffer_load_dwordx4 v[136:139], v15, s[32:35], s3 offen offset:3072 sc1
  buffer_load_dwordx4 v[140:143], v15, s[32:35], s3 offen offset:3584 sc1
  buffer_load_dwordx4 v[128:131], v15, s[32:35], s3 offen offset:1024 sc1
  buffer_load_dwordx4 v[132:135], v15, s[32:35], s3 offen offset:1536 sc1
  s_mov_b64 exec, -1
  ds_read_b64_tr_b16 a[176:177], v48 offset:45056
  ds_read_b64_tr_b16 a[178:179], v48 offset:46080
  ds_read_b64_tr_b16 a[180:181], v49 offset:45056
  ds_read_b64_tr_b16 a[182:183], v49 offset:46080
  ds_read_b64_tr_b16 a[184:185], v48 offset:45568
  ds_read_b64_tr_b16 a[186:187], v48 offset:46592
  ds_read_b64_tr_b16 a[188:189], v49 offset:45568
  ds_read_b64_tr_b16 a[190:191], v49 offset:46592
  ds_read_b64_tr_b16 a[192:193], v48 offset:49152
  ds_read_b64_tr_b16 a[194:195], v48 offset:50176
  ds_read_b64_tr_b16 a[196:197], v49 offset:49152
  ds_read_b64_tr_b16 a[198:199], v49 offset:50176
  ds_read_b64_tr_b16 a[200:201], v48 offset:49664
  ds_read_b64_tr_b16 a[202:203], v48 offset:50688
  ds_read_b64_tr_b16 a[204:205], v49 offset:49664
  ds_read_b64_tr_b16 a[206:207], v49 offset:50688
  s_cmp_ge_u32 s61, 2
  s_cselect_b32 s34, 0x1000000, 0
  s_sub_u32 s3, s12, 8192
  buffer_load_dwordx4 v[68:71], v2, s[32:35], s3 offen offset:2048 sc1
  buffer_load_dwordx4 v[64:67], v2, s[32:35], s3 offen offset:0 sc1
  s_mov_b64 exec, s[8:9]
  buffer_load_dwordx4 v[120:123], v15, s[32:35], s3 offen offset:3072 sc1
  buffer_load_dwordx4 v[124:127], v15, s[32:35], s3 offen offset:3584 sc1
  buffer_load_dwordx4 v[112:115], v15, s[32:35], s3 offen offset:1024 sc1
  buffer_load_dwordx4 v[116:119], v15, s[32:35], s3 offen offset:1536 sc1
  s_mov_b64 exec, -1
  ds_read_b64_tr_b16 a[208:209], v48 offset:53248
  ds_read_b64_tr_b16 a[210:211], v48 offset:54272
  ds_read_b64_tr_b16 a[212:213], v49 offset:53248
  ds_read_b64_tr_b16 a[214:215], v49 offset:54272
  ds_read_b64_tr_b16 a[216:217], v48 offset:53760
  ds_read_b64_tr_b16 a[218:219], v48 offset:54784
L_pad3:
  s_cbranch_execz L_pad7
  ds_read_b64_tr_b16 a[220:221], v49 offset:53760
  ds_read_b64_tr_b16 a[222:223], v49 offset:54784
  ds_read_b64_tr_b16 a[224:225], v48 offset:57344
  ds_read_b64_tr_b16 a[226:227], v48 offset:58368
  ds_read_b64_tr_b16 a[228:229], v49 offset:57344
  ds_read_b64_tr_b16 a[230:231], v49 offset:58368
  ds_read_b64_tr_b16 a[232:233], v48 offset:57856
  ds_read_b64_tr_b16 a[234:235], v48 offset:58880
  ds_read_b64_tr_b16 a[236:237], v49 offset:57856
  ds_read_b64_tr_b16 a[238:239], v49 offset:58880
  ds_read_b64_tr_b16 a[240:241], v48 offset:61440
  ds_read_b64_tr_b16 a[242:243], v48 offset:62464
  ds_read_b64_tr_b16 a[244:245], v49 offset:61440
  ds_read_b64_tr_b16 a[246:247], v49 offset:62464
  ds_read_b64_tr_b16 a[248:249], v48 offset:61952
  ds_read_b64_tr_b16 a[250:251], v48 offset:62976
  ds_read_b64_tr_b16 a[252:253], v49 offset:61952
  ds_read_b64_tr_b16 a[254:255], v49 offset:62976
  v_mfma_f32_32x32x16_bf16 v[144:159], v[24:27], v[16:19], v[192:207]
  s_nop 11
  v_exp_f32 v144, v144
  v_exp_f32 v145, v145
  v_exp_f32 v146, v146
  v_cvt_pk_bf16_f32 v176, v144, v145
  v_exp_f32 v147, v147
  v_exp_f32 v148, v148
  v_cvt_pk_bf16_f32 v177, v146, v147
  v_exp_f32 v149, v149
  v_mfma_f32_32x32x16_bf16 v[160:175], v[24:27], v[20:23], 0
  v_exp_f32 v150, v150
  v_cvt_pk_bf16_f32 v178, v148, v149
  v_exp_f32 v151, v151
  v_exp_f32 v152, v152
  v_cvt_pk_bf16_f32 v179, v150, v151
  v_exp_f32 v153, v153
  v_exp_f32 v154, v154
  v_mfma_f32_32x32x16_bf16 v[224:239], v[32:35], v[176:179], 0
  v_cvt_pk_bf16_f32 v180, v152, v153
  v_exp_f32 v155, v155
  v_exp_f32 v156, v156
  v_cvt_pk_bf16_f32 v181, v154, v155
  v_exp_f32 v157, v157
  v_exp_f32 v158, v158
  v_cvt_pk_bf16_f32 v182, v156, v157
  v_exp_f32 v159, v159
  v_exp_f32 v160, v160
  v_cvt_pk_bf16_f32 v183, v158, v159
  v_exp_f32 v161, v161
  v_exp_f32 v162, v162
  v_mfma_f32_32x32x16_bf16 v[224:239], v[36:39], v[180:183], v[224:239]
  s_cmp_ge_u32 s61, 3
  s_cselect_b32 s34, 0x1000000, 0
  s_sub_u32 s3, s12, 12288
  buffer_load_dwordx4 v[60:63], v2, s[32:35], s3 offen offset:2048 sc1
  buffer_load_dwordx4 v[56:59], v2, s[32:35], s3 offen offset:0 sc1
  s_mov_b64 exec, s[8:9]
  buffer_load_dwordx4 v[104:107], v15, s[32:35], s3 offen offset:3072 sc1
  buffer_load_dwordx4 v[108:111], v15, s[32:35], s3 offen offset:3584 sc1
  buffer_load_dwordx4 v[96:99], v15, s[32:35], s3 offen offset:1024 sc1
  buffer_load_dwordx4 v[100:103], v15, s[32:35], s3 offen offset:1536 sc1
  s_mov_b64 exec, -1
  v_cvt_pk_bf16_f32 v184, v160, v161
  v_exp_f32 v163, v163
  v_exp_f32 v164, v164
  v_cvt_pk_bf16_f32 v185, v162, v163
  v_exp_f32 v165, v165
  v_mfma_f32_32x32x16_bf16 v[144:159], v[28:31], v[20:23], v[192:207]
  v_exp_f32 v166, v166
  v_cvt_pk_bf16_f32 v186, v164, v165
  v_exp_f32 v167, v167
  v_exp_f32 v168, v168
  v_cvt_pk_bf16_f32 v187, v166, v167
  v_exp_f32 v169, v169
  v_exp_f32 v170, v170
  v_mfma_f32_32x32x16_bf16 v[240:255], v[32:35], v[184:187], 0
  v_cvt_pk_bf16_f32 v188, v168, v169
  v_exp_f32 v171, v171
  v_exp_f32 v172, v172
  v_cvt_pk_bf16_f32 v189, v170, v171
  v_exp_f32 v173, v173
  v_exp_f32 v174, v174
  v_cvt_pk_bf16_f32 v190, v172, v173
  v_exp_f32 v175, v175
  v_exp_f32 v144, v144
  v_cvt_pk_bf16_f32 v191, v174, v175
  v_exp_f32 v145, v145
  v_exp_f32 v146, v146
  v_mfma_f32_32x32x16_bf16 v[240:255], v[36:39], v[188:191], v[240:255]
  v_cvt_pk_bf16_f32 v176, v144, v145
  v_exp_f32 v147, v147
  v_exp_f32 v148, v148
  v_cvt_pk_bf16_f32 v177, v146, v147
  v_exp_f32 v149, v149
  s_waitcnt vmcnt(12)
  v_mfma_f32_32x32x16_bf16 v[160:175], v[76:79], v[16:19], 0
  v_exp_f32 v150, v150
  v_cvt_pk_bf16_f32 v178, v148, v149
  v_exp_f32 v151, v151
  v_exp_f32 v152, v152
  v_cvt_pk_bf16_f32 v179, v150, v151
  v_exp_f32 v153, v153
  v_exp_f32 v154, v154
  v_mfma_f32_32x32x16_bf16 v[240:255], v[40:43], v[176:179], v[240:255]
  s_cmp_ge_u32 s61, 4
  s_cselect_b32 s34, 0x1000000, 0
  s_sub_u32 s3, s12, 16384
  buffer_load_dwordx4 v[52:55], v2, s[32:35], s3 offen offset:2048 sc1
  buffer_load_dwordx4 v[48:51], v2, s[32:35], s3 offen offset:0 sc1
  s_mov_b64 exec, s[8:9]
  buffer_load_dwordx4 v[88:91], v15, s[32:35], s3 offen offset:3072 sc1
  buffer_load_dwordx4 v[92:95], v15, s[32:35], s3 offen offset:3584 sc1
  buffer_load_dwordx4 v[80:83], v15, s[32:35], s3 offen offset:1024 sc1
  buffer_load_dwordx4 v[84:87], v15, s[32:35], s3 offen offset:1536 sc1
  s_mov_b64 exec, -1
  v_cvt_pk_bf16_f32 v180, v152, v153
  v_exp_f32 v155, v155
  v_exp_f32 v156, v156
  v_cvt_pk_bf16_f32 v181, v154, v155
  v_exp_f32 v157, v157
  v_exp_f32 v158, v158
  v_cvt_pk_bf16_f32 v182, v156, v157
  v_exp_f32 v159, v159
  v_exp_f32 v160, v160
  v_cvt_pk_bf16_f32 v183, v158, v159
  v_exp_f32 v161, v161
  v_exp_f32 v162, v162
  v_mfma_f32_32x32x16_bf16 v[240:255], v[44:47], v[180:183], v[240:255]
  buffer_load_dwordx4 v7, s[40:43], s76 offen offset:2048  lds
  v_cvt_pk_bf16_f32 v184, v160, v161
  v_exp_f32 v163, v163
  v_exp_f32 v164, v164
  v_cvt_pk_bf16_f32 v185, v162, v163
  v_exp_f32 v165, v165
  v_mfma_f32_32x32x16_bf16 v[144:159], v[76:79], v[20:23], 0
  v_exp_f32 v166, v166
  v_cvt_pk_bf16_f32 v186, v164, v165
  v_exp_f32 v167, v167
  v_exp_f32 v168, v168
  v_cvt_pk_bf16_f32 v187, v166, v167
  v_exp_f32 v169, v169
  v_exp_f32 v170, v170
  v_mfma_f32_32x32x16_bf16 v[224:239], v[136:139], v[184:187], v[224:239]
  v_cvt_pk_bf16_f32 v188, v168, v169
  v_exp_f32 v171, v171
  v_exp_f32 v172, v172
  v_cvt_pk_bf16_f32 v189, v170, v171
  v_exp_f32 v173, v173
  v_exp_f32 v174, v174
  v_cvt_pk_bf16_f32 v190, v172, v173
  v_exp_f32 v175, v175
  v_exp_f32 v144, v144
  v_cvt_pk_bf16_f32 v191, v174, v175
  v_exp_f32 v145, v145
  v_exp_f32 v146, v146
  v_mfma_f32_32x32x16_bf16 v[224:239], v[140:143], v[188:191], v[224:239]
  buffer_load_dwordx4 v8, s[40:43], s76 offen offset:3072  lds
  s_add_u32 m0, s73, 114688
  s_mul_i32 s76, s73, 28
  s_add_u32 s76, s76, 1376384
  v_cvt_pk_bf16_f32 v176, v144, v145
  v_exp_f32 v147, v147
  v_exp_f32 v148, v148
  v_cvt_pk_bf16_f32 v177, v146, v147
  v_exp_f32 v149, v149
  v_mfma_f32_32x32x16_bf16 v[160:175], v[72:75], v[16:19], 0
  buffer_load_dwordx4 v5, s[40:43], s76 offen offset:0  lds
  v_exp_f32 v150, v150
  v_cvt_pk_bf16_f32 v178, v148, v149
  v_exp_f32 v151, v151
  v_exp_f32 v152, v152
  v_cvt_pk_bf16_f32 v179, v150, v151
  v_exp_f32 v153, v153
  v_exp_f32 v154, v154
  v_mfma_f32_32x32x16_bf16 v[240:255], v[136:139], v[176:179], v[240:255]
  v_cvt_pk_bf16_f32 v180, v152, v153
  v_exp_f32 v155, v155
  v_exp_f32 v156, v156
  v_cvt_pk_bf16_f32 v181, v154, v155
  v_exp_f32 v157, v157
  v_exp_f32 v158, v158
  v_cvt_pk_bf16_f32 v182, v156, v157
  v_exp_f32 v159, v159
  v_exp_f32 v160, v160
  v_cvt_pk_bf16_f32 v183, v158, v159
  v_exp_f32 v161, v161
  v_exp_f32 v162, v162
  v_mfma_f32_32x32x16_bf16 v[240:255], v[140:143], v[180:183], v[240:255]
  buffer_load_dwordx4 v6, s[40:43], s76 offen offset:1024  lds
  v_cvt_pk_bf16_f32 v184, v160, v161
  v_exp_f32 v163, v163
  v_exp_f32 v164, v164
  v_cvt_pk_bf16_f32 v185, v162, v163
  v_exp_f32 v165, v165
  v_mfma_f32_32x32x16_bf16 v[144:159], v[72:75], v[20:23], 0
  v_exp_f32 v166, v166
  v_cvt_pk_bf16_f32 v186, v164, v165
  v_exp_f32 v167, v167
  v_exp_f32 v168, v168
  v_cvt_pk_bf16_f32 v187, v166, v167
  v_exp_f32 v169, v169
  v_exp_f32 v170, v170
  v_mfma_f32_32x32x16_bf16 v[224:239], v[128:131], v[184:187], v[224:239]
  buffer_load_dwordx4 v7, s[40:43], s76 offen offset:2048  lds
  v_cvt_pk_bf16_f32 v188, v168, v169
  v_exp_f32 v171, v171
  v_exp_f32 v172, v172
  v_cvt_pk_bf16_f32 v189, v170, v171
  v_exp_f32 v173, v173
  v_exp_f32 v174, v174
  v_cvt_pk_bf16_f32 v190, v172, v173
  v_exp_f32 v175, v175
  v_exp_f32 v144, v144
  v_cvt_pk_bf16_f32 v191, v174, v175
  v_exp_f32 v145, v145
  v_exp_f32 v146, v146
  v_mfma_f32_32x32x16_bf16 v[224:239], v[132:135], v[188:191], v[224:239]
  buffer_load_dwordx4 v8, s[40:43], s76 offen offset:3072  lds
  v_cvt_pk_bf16_f32 v176, v144, v145
  v_exp_f32 v147, v147
  v_exp_f32 v148, v148
  v_cvt_pk_bf16_f32 v177, v146, v147
  v_exp_f32 v149, v149
  s_waitcnt vmcnt(18)
  v_mfma_f32_32x32x16_bf16 v[160:175], v[68:71], v[16:19], 0
  v_exp_f32 v150, v150
  v_cvt_pk_bf16_f32 v178, v148, v149
  v_exp_f32 v151, v151
  v_exp_f32 v152, v152
  v_cvt_pk_bf16_f32 v179, v150, v151
  v_exp_f32 v153, v153
  v_exp_f32 v154, v154
  v_mfma_f32_32x32x16_bf16 v[240:255], v[128:131], v[176:179], v[240:255]
  s_cmp_lt_u32 s63, 14
  s_cselect_b32 s42, 1835008, 0
  s_waitcnt lgkmcnt(0)
  s_barrier
  s_add_u32 m0, s73, 0
  s_mul_i32 s76, s73, 28
  s_add_u32 s76, s76, 0
  buffer_load_dwordx4 v5, s[40:43], s76 offen offset:0  lds
  v_cvt_pk_bf16_f32 v180, v152, v153
  v_exp_f32 v155, v155
  v_exp_f32 v156, v156
  v_cvt_pk_bf16_f32 v181, v154, v155
  v_exp_f32 v157, v157
  v_exp_f32 v158, v158
  v_cvt_pk_bf16_f32 v182, v156, v157
  v_exp_f32 v159, v159
  v_exp_f32 v160, v160
  v_cvt_pk_bf16_f32 v183, v158, v159
  v_exp_f32 v161, v161
  v_exp_f32 v162, v162
  v_mfma_f32_32x32x16_bf16 v[240:255], v[132:135], v[180:183], v[240:255]
  buffer_load_dwordx4 v6, s[40:43], s76 offen offset:1024  lds
  v_cvt_pk_bf16_f32 v184, v160, v161
  v_exp_f32 v163, v163
  v_exp_f32 v164, v164
  v_cvt_pk_bf16_f32 v185, v162, v163
  v_exp_f32 v165, v165
  v_mfma_f32_32x32x16_bf16 v[144:159], v[68:71], v[20:23], 0
  v_exp_f32 v166, v166
  v_cvt_pk_bf16_f32 v186, v164, v165
  v_exp_f32 v167, v167
  v_exp_f32 v168, v168
  v_cvt_pk_bf16_f32 v187, v166, v167
  v_exp_f32 v169, v169
  v_exp_f32 v170, v170
  v_mfma_f32_32x32x16_bf16 v[224:239], v[120:123], v[184:187], v[224:239]
  buffer_load_dwordx4 v7, s[40:43], s76 offen offset:2048  lds
  v_cvt_pk_bf16_f32 v188, v168, v169
  v_exp_f32 v171, v171
  v_exp_f32 v172, v172
  v_cvt_pk_bf16_f32 v189, v170, v171
  v_exp_f32 v173, v173
  v_exp_f32 v174, v174
  v_cvt_pk_bf16_f32 v190, v172, v173
  v_exp_f32 v175, v175
  v_exp_f32 v144, v144
  v_cvt_pk_bf16_f32 v191, v174, v175
  v_exp_f32 v145, v145
  v_exp_f32 v146, v146
  v_mfma_f32_32x32x16_bf16 v[224:239], v[124:127], v[188:191], v[224:239]
  buffer_load_dwordx4 v8, s[40:43], s76 offen offset:3072  lds
  s_add_u32 m0, s73, 16384
  s_mul_i32 s76, s73, 28
  v_cvt_pk_bf16_f32 v176, v144, v145
  v_exp_f32 v147, v147
  v_exp_f32 v148, v148
  v_cvt_pk_bf16_f32 v177, v146, v147
  v_exp_f32 v149, v149
  v_mfma_f32_32x32x16_bf16 v[160:175], v[64:67], v[16:19], 0
  v_exp_f32 v150, v150
  v_cvt_pk_bf16_f32 v178, v148, v149
  v_exp_f32 v151, v151
  v_exp_f32 v152, v152
  v_cvt_pk_bf16_f32 v179, v150, v151
  v_exp_f32 v153, v153
  v_exp_f32 v154, v154
  v_mfma_f32_32x32x16_bf16 v[240:255], v[120:123], v[176:179], v[240:255]
  v_min_u32 v3, 27, v1
  v_lshlrev_b32 v3, 6, v3
  s_lshl2_add_u32 s1, s2, s60
  s_mul_i32 s1, s1, 1792
  buffer_load_dword v3, v3, s[44:47], s1 offen
  s_add_u32 s76, s76, 458752
  v_cvt_pk_bf16_f32 v180, v152, v153
  v_exp_f32 v155, v155
  v_exp_f32 v156, v156
  v_cvt_pk_bf16_f32 v181, v154, v155
  v_exp_f32 v157, v157
  v_exp_f32 v158, v158
  v_cvt_pk_bf16_f32 v182, v156, v157
  v_exp_f32 v159, v159
  v_exp_f32 v160, v160
  v_cvt_pk_bf16_f32 v183, v158, v159
  v_exp_f32 v161, v161
  v_exp_f32 v162, v162
  v_mfma_f32_32x32x16_bf16 v[240:255], v[124:127], v[180:183], v[240:255]
  buffer_load_dwordx4 v5, s[40:43], s76 offen offset:0  lds
  v_cvt_pk_bf16_f32 v184, v160, v161
  v_exp_f32 v163, v163
  v_exp_f32 v164, v164
  v_cvt_pk_bf16_f32 v185, v162, v163
  v_exp_f32 v165, v165
  v_mfma_f32_32x32x16_bf16 v[144:159], v[64:67], v[20:23], 0
  v_exp_f32 v166, v166
  v_cvt_pk_bf16_f32 v186, v164, v165
  v_exp_f32 v167, v167
  v_exp_f32 v168, v168
  v_cvt_pk_bf16_f32 v187, v166, v167
  v_exp_f32 v169, v169
  v_exp_f32 v170, v170
  v_mfma_f32_32x32x16_bf16 v[224:239], v[112:115], v[184:187], v[224:239]
  v_cvt_pk_bf16_f32 v188, v168, v169
  v_exp_f32 v171, v171
  v_exp_f32 v172, v172
  v_cvt_pk_bf16_f32 v189, v170, v171
  v_exp_f32 v173, v173
  v_exp_f32 v174, v174
  v_cvt_pk_bf16_f32 v190, v172, v173
  v_exp_f32 v175, v175
  v_exp_f32 v144, v144
  v_cvt_pk_bf16_f32 v191, v174, v175
  v_exp_f32 v145, v145
  v_exp_f32 v146, v146
  v_mfma_f32_32x32x16_bf16 v[224:239], v[116:119], v[188:191], v[224:239]
  buffer_load_dwordx4 v6, s[40:43], s76 offen offset:1024  lds
  v_cvt_pk_bf16_f32 v176, v144, v145
  v_exp_f32 v147, v147
  v_exp_f32 v148, v148
  v_cvt_pk_bf16_f32 v177, v146, v147
  v_exp_f32 v149, v149
  s_waitcnt vmcnt(19)
  v_mfma_f32_32x32x16_bf16 v[160:175], v[60:63], v[16:19], 0
  buffer_load_dwordx4 v7, s[40:43], s76 offen offset:2048  lds
  v_exp_f32 v150, v150
  v_cvt_pk_bf16_f32 v178, v148, v149
  v_exp_f32 v151, v151
  v_exp_f32 v152, v152
  v_cvt_pk_bf16_f32 v179, v150, v151
  v_exp_f32 v153, v153
  v_exp_f32 v154, v154
  v_mfma_f32_32x32x16_bf16 v[240:255], v[112:115], v[176:179], v[240:255]
  v_cvt_pk_bf16_f32 v180, v152, v153
  v_exp_f32 v155, v155
  v_exp_f32 v156, v156
  v_cvt_pk_bf16_f32 v181, v154, v155
  v_exp_f32 v157, v157
  v_exp_f32 v158, v158
  v_cvt_pk_bf16_f32 v182, v156, v157
  v_exp_f32 v159, v159
  v_exp_f32 v160, v160
  v_cvt_pk_bf16_f32 v183, v158, v159
  v_exp_f32 v161, v161
  v_exp_f32 v162, v162
  v_mfma_f32_32x32x16_bf16 v[240:255], v[116:119], v[180:183], v[240:255]
  buffer_load_dwordx4 v8, s[40:43], s76 offen offset:3072  lds
  s_add_u32 m0, s73, 32768
  s_mul_i32 s76, s73, 28
  s_add_u32 s76, s76, 917504
  v_cvt_pk_bf16_f32 v184, v160, v161
  v_exp_f32 v163, v163
  v_exp_f32 v164, v164
  v_cvt_pk_bf16_f32 v185, v162, v163
  v_exp_f32 v165, v165
  v_mfma_f32_32x32x16_bf16 v[144:159], v[60:63], v[20:23], 0
  buffer_load_dwordx4 v5, s[40:43], s76 offen offset:0  lds
  v_exp_f32 v166, v166
  v_cvt_pk_bf16_f32 v186, v164, v165
  v_exp_f32 v167, v167
  v_exp_f32 v168, v168
  v_cvt_pk_bf16_f32 v187, v166, v167
  v_exp_f32 v169, v169
  v_exp_f32 v170, v170
  v_mfma_f32_32x32x16_bf16 v[224:239], v[104:107], v[184:187], v[224:239]
  v_cvt_pk_bf16_f32 v188, v168, v169
  v_exp_f32 v171, v171
  v_exp_f32 v172, v172
  v_cvt_pk_bf16_f32 v189, v170, v171
  v_exp_f32 v173, v173
  v_exp_f32 v174, v174
  v_cvt_pk_bf16_f32 v190, v172, v173
  v_exp_f32 v175, v175
  v_exp_f32 v144, v144
  v_cvt_pk_bf16_f32 v191, v174, v175
  v_exp_f32 v145, v145
  v_exp_f32 v146, v146
  v_mfma_f32_32x32x16_bf16 v[224:239], v[108:111], v[188:191], v[224:239]
  v_lshlrev_b32 v15, 4, v0
  s_mov_b32 s4, 268288
  buffer_load_dwordx4 v[112:115], v15, s[52:55], s4 offen sc1
  s_mov_b32 s4, 280576
  buffer_load_dwordx4 v[116:119], v15, s[52:55], s4 offen sc1
  s_mov_b32 s4, 292864
  v_cvt_pk_bf16_f32 v176, v144, v145
  v_exp_f32 v147, v147
  v_exp_f32 v148, v148
  v_cvt_pk_bf16_f32 v177, v146, v147
  v_exp_f32 v149, v149
  v_mfma_f32_32x32x16_bf16 v[160:175], v[56:59], v[16:19], 0
  buffer_load_dwordx4 v[120:123], v15, s[52:55], s4 offen sc1
  s_mov_b32 s4, 305152
  buffer_load_dwordx4 v[124:127], v15, s[52:55], s4 offen sc1
  s_mov_b32 s4, 266240
  v_exp_f32 v150, v150
  v_cvt_pk_bf16_f32 v178, v148, v149
  v_exp_f32 v151, v151
  v_exp_f32 v152, v152
  v_cvt_pk_bf16_f32 v179, v150, v151
  v_exp_f32 v153, v153
  v_exp_f32 v154, v154
  v_mfma_f32_32x32x16_bf16 v[240:255], v[104:107], v[176:179], v[240:255]
  v_cvt_pk_bf16_f32 v180, v152, v153
  v_exp_f32 v155, v155
  v_exp_f32 v156, v156
  v_cvt_pk_bf16_f32 v181, v154, v155
  v_exp_f32 v157, v157
  v_exp_f32 v158, v158
  v_cvt_pk_bf16_f32 v182, v156, v157
  v_exp_f32 v159, v159
  v_exp_f32 v160, v160
  v_cvt_pk_bf16_f32 v183, v158, v159
  v_exp_f32 v161, v161
  v_exp_f32 v162, v162
  v_mfma_f32_32x32x16_bf16 v[240:255], v[108:111], v[180:183], v[240:255]
  buffer_load_dwordx4 v[128:131], v11, s[52:55], s4 offen sc1
  s_mov_b32 s4, 278528
  buffer_load_dwordx4 v[132:135], v11, s[52:55], s4 offen sc1
  s_mov_b32 s4, 290816
  v_cvt_pk_bf16_f32 v184, v160, v161
  v_exp_f32 v163, v163
  v_exp_f32 v164, v164
  v_cvt_pk_bf16_f32 v185, v162, v163
  v_exp_f32 v165, v165
  v_mfma_f32_32x32x16_bf16 v[144:159], v[56:59], v[20:23], 0
  buffer_load_dwordx4 v[136:139], v11, s[52:55], s4 offen sc1
  s_mov_b32 s4, 303104
  buffer_load_dwordx4 v[140:143], v11, s[52:55], s4 offen sc1
  v_exp_f32 v166, v166
  v_cvt_pk_bf16_f32 v186, v164, v165
  v_exp_f32 v167, v167
  v_exp_f32 v168, v168
  v_cvt_pk_bf16_f32 v187, v166, v167
  v_exp_f32 v169, v169
  v_exp_f32 v170, v170
  v_mfma_f32_32x32x16_bf16 v[224:239], v[96:99], v[184:187], v[224:239]
  v_cvt_pk_bf16_f32 v188, v168, v169
  v_exp_f32 v171, v171
  v_exp_f32 v172, v172
  v_cvt_pk_bf16_f32 v189, v170, v171
  v_exp_f32 v173, v173
  v_exp_f32 v174, v174
  v_cvt_pk_bf16_f32 v190, v172, v173
  v_exp_f32 v175, v175
  v_exp_f32 v144, v144
  v_cvt_pk_bf16_f32 v191, v174, v175
  v_exp_f32 v145, v145
  v_exp_f32 v146, v146
  v_mfma_f32_32x32x16_bf16 v[224:239], v[100:103], v[188:191], v[224:239]
  buffer_load_dwordx4 v6, s[40:43], s76 offen offset:1024  lds
  v_cvt_pk_bf16_f32 v176, v144, v145
  v_exp_f32 v147, v147
  v_exp_f32 v148, v148
  v_cvt_pk_bf16_f32 v177, v146, v147
  v_exp_f32 v149, v149
  s_waitcnt vmcnt(25)
  v_mfma_f32_32x32x16_bf16 v[160:175], v[52:55], v[16:19], 0
  buffer_load_dwordx4 v7, s[40:43], s76 offen offset:2048  lds
  v_exp_f32 v150, v150
  v_cvt_pk_bf16_f32 v178, v148, v149
  v_exp_f32 v151, v151
  v_exp_f32 v152, v152
  v_cvt_pk_bf16_f32 v179, v150, v151
  v_exp_f32 v153, v153
  v_exp_f32 v154, v154
  v_mfma_f32_32x32x16_bf16 v[240:255], v[96:99], v[176:179], v[240:255]
  v_cvt_pk_bf16_f32 v180, v152, v153
  v_exp_f32 v155, v155
  v_exp_f32 v156, v156
  v_cvt_pk_bf16_f32 v181, v154, v155
  v_exp_f32 v157, v157
  v_exp_f32 v158, v158
  v_cvt_pk_bf16_f32 v182, v156, v157
  v_exp_f32 v159, v159
  v_exp_f32 v160, v160
  v_cvt_pk_bf16_f32 v183, v158, v159
  v_exp_f32 v161, v161
  v_exp_f32 v162, v162
  v_mfma_f32_32x32x16_bf16 v[240:255], v[100:103], v[180:183], v[240:255]
  buffer_load_dwordx4 v8, s[40:43], s76 offen offset:3072  lds
  s_add_u32 m0, s73, 49152
  s_mul_i32 s76, s73, 28
  s_add_u32 s76, s76, 1376256
  v_cvt_pk_bf16_f32 v184, v160, v161
  v_exp_f32 v163, v163
  v_exp_f32 v164, v164
  v_cvt_pk_bf16_f32 v185, v162, v163
  v_exp_f32 v165, v165
  v_mfma_f32_32x32x16_bf16 v[144:159], v[52:55], v[20:23], v[208:223]
  v_exp_f32 v166, v166
  v_cvt_pk_bf16_f32 v186, v164, v165
  v_exp_f32 v167, v167
  v_exp_f32 v168, v168
  v_cvt_pk_bf16_f32 v187, v166, v167
  v_exp_f32 v169, v169
  v_exp_f32 v170, v170
  v_mfma_f32_32x32x16_bf16 v[224:239], v[88:91], v[184:187], v[224:239]
  buffer_load_dwordx4 v5, s[40:43], s76 offen offset:0  lds
  v_cvt_pk_bf16_f32 v188, v168, v169
  v_exp_f32 v171, v171
  v_exp_f32 v172, v172
  v_cvt_pk_bf16_f32 v189, v170, v171
  v_exp_f32 v173, v173
  v_exp_f32 v174, v174
  v_cvt_pk_bf16_f32 v190, v172, v173
  v_exp_f32 v175, v175
  v_exp_f32 v144, v144
  v_cvt_pk_bf16_f32 v191, v174, v175
  v_exp_f32 v145, v145
  v_exp_f32 v146, v146
  v_mfma_f32_32x32x16_bf16 v[224:239], v[92:95], v[188:191], v[224:239]
  buffer_load_dwordx4 v6, s[40:43], s76 offen offset:1024  lds
  v_cvt_pk_bf16_f32 v176, v144, v145
  v_exp_f32 v147, v147
  v_exp_f32 v148, v148
  v_cvt_pk_bf16_f32 v177, v146, v147
  v_exp_f32 v149, v149
  v_mfma_f32_32x32x16_bf16 v[160:175], v[48:51], v[16:19], v[208:223]
  v_exp_f32 v150, v150
  v_cvt_pk_bf16_f32 v178, v148, v149
  v_exp_f32 v151, v151
  v_exp_f32 v152, v152
  v_cvt_pk_bf16_f32 v179, v150, v151
  v_exp_f32 v153, v153
  v_exp_f32 v154, v154
  v_mfma_f32_32x32x16_bf16 v[240:255], v[88:91], v[176:179], v[240:255]
  buffer_load_dwordx4 v7, s[40:43], s76 offen offset:2048  lds
  v_cvt_pk_bf16_f32 v180, v152, v153
  v_exp_f32 v155, v155
  v_exp_f32 v156, v156
  v_cvt_pk_bf16_f32 v181, v154, v155
  v_exp_f32 v157, v157
  v_exp_f32 v158, v158
  v_cvt_pk_bf16_f32 v182, v156, v157
  v_exp_f32 v159, v159
  v_exp_f32 v160, v160
  v_cvt_pk_bf16_f32 v183, v158, v159
  v_exp_f32 v161, v161
  v_exp_f32 v162, v162
  v_mfma_f32_32x32x16_bf16 v[240:255], v[92:95], v[180:183], v[240:255]
  v_cvt_pk_bf16_f32 v184, v160, v161
  v_exp_f32 v163, v163
  v_exp_f32 v164, v164
  v_cvt_pk_bf16_f32 v185, v162, v163
  v_exp_f32 v165, v165
  v_exp_f32 v166, v166
  v_cvt_pk_bf16_f32 v186, v164, v165
  v_exp_f32 v167, v167
  v_exp_f32 v168, v168
  v_cvt_pk_bf16_f32 v187, v166, v167
  v_exp_f32 v169, v169
  v_exp_f32 v170, v170
  v_mfma_f32_32x32x16_bf16 v[224:239], v[80:83], v[184:187], v[224:239]
  buffer_load_dwordx4 v8, s[40:43], s76 offen offset:3072  lds
  s_lshl4_add_u32 s11, s20, s75
  s_lshl_b32 s13, s60, 11
  v_cvt_pk_bf16_f32 v188, v168, v169
  v_exp_f32 v171, v171
  v_exp_f32 v172, v172
  v_cvt_pk_bf16_f32 v189, v170, v171
  v_exp_f32 v173, v173
  v_exp_f32 v174, v174
  v_cvt_pk_bf16_f32 v190, v172, v173
  v_exp_f32 v175, v175
  s_nop 0
  v_cvt_pk_bf16_f32 v191, v174, v175
  s_nop 1
  v_mfma_f32_32x32x16_bf16 v[224:239], v[84:87], v[188:191], v[224:239]
  s_mov_b32 s3, 0x5f800000
  s_mov_b32 s1, 0x1f800000
  s_add_u32 s64, s14, 32768
  s_nop 8
  v_max_f32 v144, v232, v248
  v_min_f32 v145, v232, v248
  v_cmp_u_f32 s[6:7], v232, v248
  v_cmp_nle_f32 s[4:5], s1, v145
  v_cmp_nge_f32 vcc, s3, v144
  s_or_b64 s[4:5], s[6:7], s[4:5]
  s_or_b64 vcc, vcc, s[4:5]
  s_cbranch_vccnz L_redo_18
L_attfin_19:
  v_rcp_f32 v232, v232
  v_rcp_f32 v248, v248
  v_pk_mul_f32 v[224:225], v[224:225], v[232:233] op_sel_hi:[1,0]
  v_pk_mul_f32 v[226:227], v[226:227], v[232:233] op_sel_hi:[1,0]
  v_pk_mul_f32 v[228:229], v[228:229], v[232:233] op_sel_hi:[1,0]
  v_pk_mul_f32 v[230:231], v[230:231], v[232:233] op_sel_hi:[1,0]
  v_cvt_pk_bf16_f32 v224, v224, v225
  v_cvt_pk_bf16_f32 v225, v226, v227
  v_cvt_pk_bf16_f32 v226, v228, v229
  v_cvt_pk_bf16_f32 v227, v230, v231
  buffer_store_dwordx4 v[224:227], v14, s[52:55], s14 offen sc1
  v_pk_mul_f32 v[240:241], v[240:241], v[248:249] op_sel_hi:[1,0]
  v_pk_mul_f32 v[242:243], v[242:243], v[248:249] op_sel_hi:[1,0]
  v_pk_mul_f32 v[244:245], v[244:245], v[248:249] op_sel_hi:[1,0]
  v_pk_mul_f32 v[246:247], v[246:247], v[248:249] op_sel_hi:[1,0]
  v_cvt_pk_bf16_f32 v240, v240, v241
  v_cvt_pk_bf16_f32 v241, v242, v243
  v_cvt_pk_bf16_f32 v242, v244, v245
  v_cvt_pk_bf16_f32 v243, v246, v247
  buffer_store_dwordx4 v[240:243], v14, s[52:55], s64 offen sc1
  s_add_u32 m0, s77, 2048
  s_add_u32 s76, s75, 0
  buffer_load_dwordx4 v9, s[44:47], s76 offen  lds
  buffer_load_dwordx4 v12, s[44:47], s76 offen offset:1024  lds
  s_add_u32 m0, s77, 4096
  s_add_u32 s76, s75, 8192
  buffer_load_dwordx4 v9, s[44:47], s76 offen  lds
  buffer_load_dwordx4 v12, s[44:47], s76 offen offset:1024  lds
  s_bfe_u32 s4, s65, 0x80000
  s_bfe_u32 s5, s65, 0x80008
  s_bfe_u32 s6, s65, 0x80010
  s_bfe_u32 s7, s65, 0x80018
  s_mov_b32 s8, 0
  s_waitcnt vmcnt(13)
L_gchk_20:
  v_xor_b32 v112, s4, v112
  v_xor_b32 v113, s5, v113
  v_xor_b32 v114, s6, v114
  v_xor_b32 v115, s7, v115
  v_xor_b32 v116, s4, v116
  v_xor_b32 v117, s5, v117
  v_xor_b32 v118, s6, v118
  v_xor_b32 v119, s7, v119
  v_xor_b32 v120, s4, v120
  v_xor_b32 v121, s5, v121
  v_xor_b32 v122, s6, v122
  v_xor_b32 v123, s7, v123
  v_xor_b32 v124, s4, v124
  v_xor_b32 v125, s5, v125
  v_xor_b32 v126, s6, v126
  v_xor_b32 v127, s7, v127
  v_xor_b32 v128, s4, v128
  v_xor_b32 v129, s5, v129
  v_xor_b32 v130, s6, v130
  v_xor_b32 v131, s7, v131
  v_xor_b32 v132, s4, v132
  v_xor_b32 v133, s5, v133
  v_xor_b32 v134, s6, v134
  v_xor_b32 v135, s7, v135
  v_xor_b32 v136, s4, v136
  v_xor_b32 v137, s5, v137
  v_xor_b32 v138, s6, v138
  v_xor_b32 v139, s7, v139
  v_xor_b32 v140, s4, v140
  v_xor_b32 v141, s5, v141
  v_xor_b32 v142, s6, v142
  v_xor_b32 v143, s7, v143
  v_or3_b32 v4, v112, v113, v114
  v_or3_b32 v4, v4, v115, v116
  v_or3_b32 v4, v4, v117, v118
  v_or3_b32 v4, v4, v119, v120
  v_or3_b32 v4, v4, v121, v122
  v_or3_b32 v4, v4, v123, v124
  v_or3_b32 v4, v4, v125, v126
  v_or3_b32 v4, v4, v127, v128
  v_or3_b32 v4, v4, v129, v130
  v_or3_b32 v4, v4, v131, v132
  v_or3_b32 v4, v4, v133, v134
  v_or3_b32 v4, v4, v135, v136
  v_or3_b32 v4, v4, v137, v138
  v_or3_b32 v4, v4, v139, v140
  v_or3_b32 v4, v4, v141, v142
  v_or_b32 v4, v4, v143
L_pad4:
  s_cbranch_execz L_body
  v_lshlrev_b32 v4, 24, v4
  v_cmp_ne_u32 vcc, 0, v4
  s_cbranch_vccnz L_gagain_21
L_gok_22:
  v_pk_add_f32 v[112:113], v[112:113], v[116:117]
  v_pk_add_f32 v[120:121], v[120:121], v[124:125]
  v_pk_add_f32 v[114:115], v[114:115], v[118:119]
  v_pk_add_f32 v[122:123], v[122:123], v[126:127]
  v_pk_add_f32 v[112:113], v[112:113], v[120:121]
  v_pk_add_f32 v[114:115], v[114:115], v[122:123]
  v_cvt_pk_bf16_f32 v112, v112, v113
  v_cvt_pk_bf16_f32 v113, v114, v115
  v_pk_add_f32 v[128:129], v[128:129], v[132:133]
  v_pk_add_f32 v[136:137], v[136:137], v[140:141]
  v_pk_add_f32 v[130:131], v[130:131], v[134:135]
  v_pk_add_f32 v[138:139], v[138:139], v[142:143]
  v_pk_add_f32 v[128:129], v[128:129], v[136:137]
  v_pk_add_f32 v[130:131], v[130:131], v[138:139]
  v_cvt_pk_bf16_f32 v128, v128, v129
  v_cvt_pk_bf16_f32 v129, v130, v131
  s_cmp_ge_u32 s60, 2
  s_cselect_b32 s3, 1.0, 0
  v_lshlrev_b32 v116, 16, v112
  v_and_b32 v117, s68, v112
  v_lshlrev_b32 v118, 16, v113
  v_and_b32 v119, s68, v113
  v_add_f32 v116, s3, v116
  v_add_f32 v117, s3, v117
  v_add_f32 v118, s3, v118
  v_add_f32 v119, s3, v119
  v_cvt_pk_bf16_f32 v112, v116, v117
  v_cvt_pk_bf16_f32 v113, v118, v119
  v_and_b32 v16, 3, v0
  v_bfe_u32 v17, v0, 2, 1
  v_lshl_add_u32 v16, v16, 1, v17
  v_lshl_add_u32 v4, s60, 3, v16
  s_movk_i32 s4, 0x78
  v_and_or_b32 v16, v0, s4, v16
  s_lshr_b32 s5, s60, 1
  s_mul_i32 s3, s5, 1088
  s_add_u32 s3, s3, 155648
  v_lshl_add_u32 v16, v16, 3, s3
  s_mov_b32 s3, 157824
  v_lshl_add_u32 v4, v4, 3, s3
  ds_write_b64 v16, v[112:113]
  ds_write_b64 v4, v[128:129]
  v_mov_b32 v17, 0
  v_lshlrev_b32 v18, 2, v0
  v_add_u32 v18, 160896, v18
  ds_write_b32 v18, v17
  s_and_b32 s7, s60, 1
  s_lshl_b32 s7, s7, 9
  s_lshl_b32 s3, s5, 16
  s_add_u32 s3, s3, s7
  v_add_u32 v201, s3, v13
  v_lshrrev_b32 v203, 5, v1
  v_and_b32 v16, 1, v1
  v_mul_u32_u24 v16, 1088, v16
  v_lshl_add_u32 v16, v203, 4, v16
  v_add_u32 v200, 155648, v16
  v_and_b32 v16, 26, v1
  v_cmp_eq_u32 vcc, 0, v16
  v_mov_b32 v16, 160896
  s_nop 0
  v_cndmask_b32 v200, v16, v200, vcc
  v_and_b32 v249, 31, v1
  v_lshlrev_b32 v252, 2, v249
  s_waitcnt vmcnt(6) lgkmcnt(0)
  s_barrier
  s_add_u32 s4, s19, 4096
  s_add_u32 s5, s19, 8192
  s_add_u32 s6, s19, 12288
  s_waitcnt vmcnt(4)
  v_mov_b32 v3, s65
  s_mov_b64 exec, 1
  s_cmp_eq_u32 s67, 0
  s_cbranch_scc1 L_slow_23
  buffer_store_dword v3, off, s[52:55], s15 offset:0
L_back_24:
  s_mov_b64 exec, -1
  ds_read_b128 v[96:99], v200 offset:0
  ds_read_b64_tr_b16 v[100:101], v201 offset:0
  ds_read_b64_tr_b16 v[102:103], v201 offset:2048
  ds_read_b128 v[104:107], v200 offset:32
  ds_read_b64_tr_b16 v[108:109], v201 offset:1024
  ds_read_b64_tr_b16 v[110:111], v201 offset:3072
  ds_read_b128 v[112:115], v200 offset:64
  ds_read_b64_tr_b16 v[116:117], v201 offset:4096
  ds_read_b64_tr_b16 v[118:119], v201 offset:6144
  ds_read_b128 v[120:123], v200 offset:96
  ds_read_b64_tr_b16 v[124:125], v201 offset:5120
  ds_read_b64_tr_b16 v[126:127], v201 offset:7168
  ds_read_b128 v[128:131], v200 offset:128
  ds_read_b64_tr_b16 v[132:133], v201 offset:8192
  ds_read_b64_tr_b16 v[134:135], v201 offset:10240
  s_waitcnt lgkmcnt(9)
  v_mfma_f32_32x32x16_bf16 v[144:159], v[96:99], v[100:103], 0
  ds_read_b128 v[136:139], v200 offset:160
  ds_read_b64_tr_b16 v[140:141], v201 offset:9216
  ds_read_b64_tr_b16 v[142:143], v201 offset:11264
  v_mfma_f32_32x32x16_bf16 v[144:159], v[104:107], v[108:111], v[144:159]
  s_waitcnt lgkmcnt(6)
  v_mfma_f32_32x32x16_bf16 v[144:159], v[112:115], v[116:119], v[144:159]
  v_mfma_f32_32x32x16_bf16 v[144:159], v[120:123], v[124:127], v[144:159]
  s_waitcnt lgkmcnt(0)
  v_mfma_f32_32x32x16_bf16 v[144:159], v[128:131], v[132:135], v[144:159]
  buffer_load_dword v3, v252, s[52:55], s18 offen offset:0 sc1
  v_mfma_f32_32x32x16_bf16 v[144:159], v[136:139], v[140:143], v[144:159]
  s_waitcnt vmcnt(0)
  v_cmp_ne_u32 vcc, s65, v3
  s_cbranch_vccnz L_pagain_25
L_pok_27:
  buffer_load_dwordx4 v[16:19], v2, s[52:55], s19 offen offset:0 sc1
  buffer_load_dwordx4 v[20:23], v2, s[52:55], s19 offen offset:1024 sc1
  buffer_load_dwordx4 v[24:27], v2, s[52:55], s19 offen offset:2048 sc1
  buffer_load_dwordx4 v[28:31], v2, s[52:55], s19 offen offset:3072 sc1
  buffer_load_dwordx4 v[32:35], v2, s[52:55], s4 offen offset:0 sc1
  buffer_load_dwordx4 v[36:39], v2, s[52:55], s4 offen offset:1024 sc1
  buffer_load_dwordx4 v[40:43], v2, s[52:55], s4 offen offset:2048 sc1
  buffer_load_dwordx4 v[44:47], v2, s[52:55], s4 offen offset:3072 sc1
  buffer_load_dwordx4 v[48:51], v2, s[52:55], s5 offen offset:0 sc1
  buffer_load_dwordx4 v[52:55], v2, s[52:55], s5 offen offset:1024 sc1
  buffer_load_dwordx4 v[56:59], v2, s[52:55], s5 offen offset:2048 sc1
  buffer_load_dwordx4 v[60:63], v2, s[52:55], s5 offen offset:3072 sc1
  v_and_b32 v96, 48, v1
  v_add_u32 v97, 157824, v96
  s_lshl_b32 s3, s62, 7
  s_add_u32 s3, s3, 156736
  v_add_u32 v98, s3, v96
  v_and_b32 v101, 15, v1
  v_lshrrev_b32 v102, 1, v96
  v_lshl_add_u32 v102, v101, 7, v102
  v_add_u32 v102, s77, v102
  ds_read_b64 v[120:121], v102 offset:0
  ds_read_b64 v[122:123], v102 offset:32
  ds_read_b64 v[124:125], v102 offset:64
  ds_read_b64 v[126:127], v102 offset:96
  ds_read_b128 v[104:107], v97 offset:0
  ds_read_b128 v[112:115], v98 offset:0
  ds_read_b128 v[240:243], v97 offset:128
  ds_read_b128 v[108:111], v97 offset:64
  ds_read_b128 v[116:119], v98 offset:64
  ds_read_b128 v[244:247], v97 offset:192
  v_bfe_u32 v99, v1, 4, 1
  v_lshl_add_u32 v100, v99, 8, v13
  v_mul_u32_u24 v103, 768, v203
  v_add_u32 v100, v100, v103
  v_add_u32 v180, s77, v100
  v_xor_b32 v181, 32, v180
  v_lshlrev_b32 v103, 4, v249
  v_add_u32 v248, 158208, v103
  s_lshl_b32 s3, s60, 9
  v_add_u32 v202, s3, v248
  s_waitcnt vmcnt(11)
  v_mfma_f32_16x16x32_bf16 v[80:83], a[0:3], v[16:19], 0
  buffer_load_dwordx4 v[64:67], v2, s[52:55], s6 offen offset:0 sc1
  v_mfma_f32_16x16x32_bf16 v[84:87], a[4:7], v[16:19], 0
  s_waitcnt lgkmcnt(0)
  v_lshlrev_b32 v184, 16, v120
  v_mfma_f32_16x16x32_bf16 v[88:91], a[8:11], v[16:19], 0
  v_and_b32 v185, s68, v120
  v_lshlrev_b32 v208, 16, v104
  v_mfma_f32_16x16x32_bf16 v[92:95], a[12:15], v[16:19], 0
  v_and_b32 v209, s68, v104
  s_waitcnt vmcnt(10)
  v_mfma_f32_16x16x32_bf16 v[80:83], a[16:19], v[20:23], v[80:83]
  buffer_load_dwordx4 v[68:71], v2, s[52:55], s6 offen offset:1024 sc1
  v_mfma_f32_16x16x32_bf16 v[80:83], a[32:35], v[24:27], v[80:83]
  v_lshlrev_b32 v224, 16, v112
  v_and_b32 v225, s68, v112
  v_mfma_f32_16x16x32_bf16 v[84:87], a[20:23], v[20:23], v[84:87]
  v_lshlrev_b32 v186, 16, v121
  v_and_b32 v187, s68, v121
  v_mfma_f32_16x16x32_bf16 v[84:87], a[36:39], v[24:27], v[84:87]
  v_lshlrev_b32 v210, 16, v105
  v_and_b32 v211, s68, v105
  v_mfma_f32_16x16x32_bf16 v[88:91], a[24:27], v[20:23], v[88:91]
  buffer_load_dwordx4 v[72:75], v2, s[52:55], s6 offen offset:2048 sc1
  v_mfma_f32_16x16x32_bf16 v[88:91], a[40:43], v[24:27], v[88:91]
  v_lshlrev_b32 v226, 16, v113
  v_and_b32 v227, s68, v113
  v_mfma_f32_16x16x32_bf16 v[92:95], a[28:31], v[20:23], v[92:95]
  v_lshlrev_b32 v188, 16, v122
  v_and_b32 v189, s68, v122
  v_mfma_f32_16x16x32_bf16 v[92:95], a[44:47], v[24:27], v[92:95]
  v_lshlrev_b32 v212, 16, v106
  s_waitcnt vmcnt(10)
  v_mfma_f32_16x16x32_bf16 v[80:83], a[48:51], v[28:31], v[80:83]
  buffer_load_dwordx4 v[76:79], v2, s[52:55], s6 offen offset:3072 sc1
  v_mfma_f32_16x16x32_bf16 v[80:83], a[64:67], v[32:35], v[80:83]
  v_and_b32 v213, s68, v106
  v_lshlrev_b32 v228, 16, v114
  v_mfma_f32_16x16x32_bf16 v[84:87], a[52:55], v[28:31], v[84:87]
  v_and_b32 v229, s68, v114
  v_lshlrev_b32 v190, 16, v123
  v_mfma_f32_16x16x32_bf16 v[84:87], a[68:71], v[32:35], v[84:87]
  v_and_b32 v191, s68, v123
  v_lshlrev_b32 v214, 16, v107
  v_mfma_f32_16x16x32_bf16 v[88:91], a[56:59], v[28:31], v[88:91]
  s_add_u32 m0, s77, 0
  s_add_u32 s76, s11, 0
  buffer_load_dwordx4 v9, s[44:47], s76 offen  lds
  v_mfma_f32_16x16x32_bf16 v[88:91], a[72:75], v[32:35], v[88:91]
  v_and_b32 v215, s68, v107
  v_lshlrev_b32 v230, 16, v115
  v_mfma_f32_16x16x32_bf16 v[92:95], a[60:63], v[28:31], v[92:95]
  v_and_b32 v231, s68, v115
  v_lshlrev_b32 v192, 16, v124
  v_mfma_f32_16x16x32_bf16 v[92:95], a[76:79], v[32:35], v[92:95]
  v_and_b32 v193, s68, v124
  s_waitcnt vmcnt(10)
  v_mfma_f32_16x16x32_bf16 v[80:83], a[80:83], v[36:39], v[80:83]
  buffer_load_dwordx4 v12, s[44:47], s76 offen offset:1024  lds
  v_mfma_f32_16x16x32_bf16 v[80:83], a[96:99], v[40:43], v[80:83]
  ds_read_b64_tr_b16 a[32:33], v180 offset:2048
  v_lshlrev_b32 v216, 16, v108
  v_mfma_f32_16x16x32_bf16 v[84:87], a[84:87], v[36:39], v[84:87]
  ds_read_b64_tr_b16 a[36:37], v181 offset:2048
  v_and_b32 v217, s68, v108
  v_mfma_f32_16x16x32_bf16 v[84:87], a[100:103], v[40:43], v[84:87]
  ds_read_b64_tr_b16 a[40:41], v180 offset:2560
  v_lshlrev_b32 v232, 16, v116
  v_mfma_f32_16x16x32_bf16 v[88:91], a[88:91], v[36:39], v[88:91]
  v_mfma_f32_16x16x32_bf16 v[88:91], a[104:107], v[40:43], v[88:91]
  ds_read_b64_tr_b16 a[44:45], v181 offset:2560
  v_and_b32 v233, s68, v116
  v_mfma_f32_16x16x32_bf16 v[92:95], a[92:95], v[36:39], v[92:95]
  ds_read_b64_tr_b16 a[34:35], v180 offset:4096
  v_lshlrev_b32 v194, 16, v125
  v_mfma_f32_16x16x32_bf16 v[92:95], a[108:111], v[40:43], v[92:95]
  v_and_b32 v195, s68, v125
  s_waitcnt vmcnt(9)
  v_mfma_f32_16x16x32_bf16 v[80:83], a[112:115], v[44:47], v[80:83]
  v_mfma_f32_16x16x32_bf16 v[80:83], a[128:131], v[48:51], v[80:83]
  ds_read_b64_tr_b16 a[38:39], v181 offset:4096
  v_lshlrev_b32 v218, 16, v109
  v_mfma_f32_16x16x32_bf16 v[84:87], a[116:119], v[44:47], v[84:87]
  ds_read_b64_tr_b16 a[42:43], v180 offset:4608
  v_and_b32 v219, s68, v109
  v_mfma_f32_16x16x32_bf16 v[84:87], a[132:135], v[48:51], v[84:87]
  ds_read_b64_tr_b16 a[46:47], v181 offset:4608
  v_lshlrev_b32 v234, 16, v117
  v_mfma_f32_16x16x32_bf16 v[88:91], a[120:123], v[44:47], v[88:91]
  v_mfma_f32_16x16x32_bf16 v[88:91], a[136:139], v[48:51], v[88:91]
  s_waitcnt lgkmcnt(0)
  v_and_b32 v235, s68, v117
  v_mfma_f32_16x16x32_bf16 v[92:95], a[124:127], v[44:47], v[92:95]
  v_lshlrev_b32 v196, 16, v126
  v_and_b32 v197, s68, v126
  v_mfma_f32_16x16x32_bf16 v[92:95], a[140:143], v[48:51], v[92:95]
  v_lshlrev_b32 v220, 16, v110
  s_waitcnt vmcnt(7)
  v_mfma_f32_16x16x32_bf16 v[80:83], a[144:147], v[52:55], v[80:83]
  s_add_u32 m0, s77, 2048
  s_add_u32 s76, s11, 8192
  buffer_load_dwordx4 v9, s[44:47], s76 offen  lds
  v_mfma_f32_16x16x32_bf16 v[80:83], a[160:163], v[56:59], v[80:83]
  v_and_b32 v221, s68, v110
  v_lshlrev_b32 v236, 16, v118
  v_mfma_f32_16x16x32_bf16 v[84:87], a[148:151], v[52:55], v[84:87]
  v_and_b32 v237, s68, v118
  v_lshlrev_b32 v198, 16, v127
  v_mfma_f32_16x16x32_bf16 v[84:87], a[164:167], v[56:59], v[84:87]
  v_and_b32 v199, s68, v127
  v_lshlrev_b32 v222, 16, v111
  v_mfma_f32_16x16x32_bf16 v[88:91], a[152:155], v[52:55], v[88:91]
  buffer_load_dwordx4 v12, s[44:47], s76 offen offset:1024  lds
  v_mfma_f32_16x16x32_bf16 v[88:91], a[168:171], v[56:59], v[88:91]
  v_and_b32 v223, s68, v111
  v_lshlrev_b32 v238, 16, v119
  v_mfma_f32_16x16x32_bf16 v[92:95], a[156:159], v[52:55], v[92:95]
  v_and_b32 v239, s68, v119
  v_lshlrev_b32 v253, 5, v96
  v_mfma_f32_16x16x32_bf16 v[92:95], a[172:175], v[56:59], v[92:95]
  v_lshl_add_u32 v253, v101, 4, v253
  s_waitcnt vmcnt(7)
  v_mfma_f32_16x16x32_bf16 v[80:83], a[176:179], v[60:63], v[80:83]
  s_add_u32 m0, s77, 4096
  s_add_u32 s76, s75, 131072
  buffer_load_dwordx4 v9, s[44:47], s76 offen  lds
  v_mfma_f32_16x16x32_bf16 v[80:83], a[192:195], v[64:67], v[80:83]
  v_lshlrev_b32 v178, 6, v203
  v_lshl_add_u32 v178, v101, 2, v178
  v_mfma_f32_16x16x32_bf16 v[84:87], a[180:183], v[60:63], v[84:87]
  v_mfma_f32_16x16x32_bf16 v[84:87], a[196:199], v[64:67], v[84:87]
  v_mfma_f32_16x16x32_bf16 v[88:91], a[184:187], v[60:63], v[88:91]
  buffer_load_dwordx4 v12, s[44:47], s76 offen offset:1024  lds
  v_mfma_f32_16x16x32_bf16 v[88:91], a[200:203], v[64:67], v[88:91]
  v_mfma_f32_16x16x32_bf16 v[92:95], a[188:191], v[60:63], v[92:95]
  v_mfma_f32_16x16x32_bf16 v[92:95], a[204:207], v[64:67], v[92:95]
  s_waitcnt vmcnt(7)
  v_mfma_f32_16x16x32_bf16 v[80:83], a[208:211], v[68:71], v[80:83]
  v_mfma_f32_16x16x32_bf16 v[80:83], a[224:227], v[72:75], v[80:83]
  v_mfma_f32_16x16x32_bf16 v[84:87], a[212:215], v[68:71], v[84:87]
  v_mfma_f32_16x16x32_bf16 v[84:87], a[228:231], v[72:75], v[84:87]
  v_mfma_f32_16x16x32_bf16 v[88:91], a[216:219], v[68:71], v[88:91]
  v_mfma_f32_16x16x32_bf16 v[88:91], a[232:235], v[72:75], v[88:91]
  v_mfma_f32_16x16x32_bf16 v[92:95], a[220:223], v[68:71], v[92:95]
  v_mfma_f32_16x16x32_bf16 v[92:95], a[236:239], v[72:75], v[92:95]
  s_waitcnt vmcnt(6)
  v_mfma_f32_16x16x32_bf16 v[80:83], a[240:243], v[76:79], v[80:83]
  v_mfma_f32_16x16x32_bf16 v[84:87], a[244:247], v[76:79], v[84:87]
  v_mfma_f32_16x16x32_bf16 v[88:91], a[248:251], v[76:79], v[88:91]
  v_mfma_f32_16x16x32_bf16 v[92:95], a[252:255], v[76:79], v[92:95]
  s_cmp_lt_u32 s63, 14
  s_cselect_b32 s34, 0x1000000, 0
  s_nop 2
  v_pk_fma_f32 v[184:185], v[80:81], v[208:209], v[184:185]
  v_pk_fma_f32 v[186:187], v[82:83], v[210:211], v[186:187]
  v_pk_fma_f32 v[188:189], v[84:85], v[212:213], v[188:189]
  v_pk_fma_f32 v[190:191], v[86:87], v[214:215], v[190:191]
  v_pk_mul_f32 v[224:225], v[224:225], v[184:185]
  v_pk_mul_f32 v[226:227], v[226:227], v[186:187]
  v_pk_mul_f32 v[228:229], v[228:229], v[188:189]
  v_pk_mul_f32 v[230:231], v[230:231], v[190:191]
  v_cvt_pk_bf16_f32 v224, v224, v225
  v_cvt_pk_bf16_f32 v225, v226, v227
  v_cvt_pk_bf16_f32 v226, v228, v229
  v_cvt_pk_bf16_f32 v227, v230, v231
  buffer_store_dwordx4 v[224:227], v253, s[52:55], s22 offen offset:0 sc1
  v_pk_fma_f32 v[192:193], v[88:89], v[216:217], v[192:193]
  v_pk_fma_f32 v[194:195], v[90:91], v[218:219], v[194:195]
  v_pk_fma_f32 v[196:197], v[92:93], v[220:221], v[196:197]
  v_pk_fma_f32 v[198:199], v[94:95], v[222:223], v[198:199]
  v_pk_mul_f32 v[232:233], v[232:233], v[192:193]
  v_pk_mul_f32 v[234:235], v[234:235], v[194:195]
  v_pk_mul_f32 v[236:237], v[236:237], v[196:197]
  v_pk_mul_f32 v[238:239], v[238:239], v[198:199]
  v_cvt_pk_bf16_f32 v232, v232, v233
  v_cvt_pk_bf16_f32 v233, v234, v235
  v_cvt_pk_bf16_f32 v234, v236, v237
  v_cvt_pk_bf16_f32 v235, v238, v239
  buffer_store_dwordx4 v[232:235], v253, s[52:55], s22 offen offset:2048 sc1
  v_pk_add_f32 v[208:209], v[184:185], v[186:187]
  v_pk_mul_f32 v[210:211], v[184:185], v[184:185]
  v_pk_fma_f32 v[210:211], v[186:187], v[186:187], v[210:211]
  v_pk_add_f32 v[208:209], v[208:209], v[188:189]
  v_pk_fma_f32 v[210:211], v[188:189], v[188:189], v[210:211]
  v_pk_add_f32 v[208:209], v[208:209], v[190:191]
  v_pk_fma_f32 v[210:211], v[190:191], v[190:191], v[210:211]
  v_pk_add_f32 v[208:209], v[208:209], v[192:193]
  v_pk_fma_f32 v[210:211], v[192:193], v[192:193], v[210:211]
  v_pk_add_f32 v[208:209], v[208:209], v[194:195]
  v_pk_fma_f32 v[210:211], v[194:195], v[194:195], v[210:211]
  v_pk_add_f32 v[208:209], v[208:209], v[196:197]
  v_pk_fma_f32 v[210:211], v[196:197], v[196:197], v[210:211]
  v_pk_add_f32 v[208:209], v[208:209], v[198:199]
  v_pk_fma_f32 v[210:211], v[198:199], v[198:199], v[210:211]
  v_add_f32 v208, v208, v209
  v_add_f32 v209, v210, v211
  v_lshl_add_u32 v179, v99, 7, v178
  v_add_u32 v182, s13, v100
  v_permlane32_swap_b32 v208, v209
  v_add_f32 v208, v208, v209
  v_mov_b32 v209, v208
  s_nop 1
  v_permlane16_swap_b32 v208, v209
  v_add_f32 v208, v208, v209
  buffer_store_dword v208, v178, s[52:55], s23 offen sc1
  v_xor_b32 v183, 32, v182
  v_mul_u32_u24 v103, 57344, v99
  v_lshl_add_u32 v253, v178, 2, v103
  v_lshlrev_b32 v103, 10, v101
  v_lshl_add_u32 v103, v99, 5, v103
  v_lshl_add_u32 v177, v203, 4, v103
  s_lshr_b32 s3, s20, 1
  v_add_u32 v250, s3, v2
  s_bitcmp1_b32 s60, 0
  s_cselect_b32 s10, s11, s75
  s_cselect_b32 s12, s75, s11
  s_cselect_b32 s4, s3, 0
  s_cselect_b32 s3, 0, s3
  v_add_u32 v236, s4, v2
  v_add_u32 v237, s3, v2
  s_lshr_b32 s3, s21, 8
  s_and_b32 s3, s3, 0x1c0
  s_add_u32 s3, s3, 160256
  v_lshl_add_u32 v176, v101, 2, s3
  v_add_u32 v10, 65536, v182
  v_add_u32 v11, 65536, v183
  v_add_u32 v14, 65536, v13
  v_and_b32 v254, 60, v252
  s_mul_i32 s3, s60, 28
  s_andn2_b32 s3, s3, 7
  v_and_b32 v103, 28, v252
  v_add_u32 v251, s3, v103
  s_waitcnt vmcnt(5)
  ds_read_b64_tr_b16 a[48:49], v180 offset:0
  ds_read_b64_tr_b16 a[52:53], v181 offset:0
  ds_read_b64_tr_b16 a[56:57], v180 offset:512
  ds_read_b64_tr_b16 a[60:61], v181 offset:512
  ds_read_b64_tr_b16 a[50:51], v180 offset:2048
  ds_read_b64_tr_b16 a[54:55], v181 offset:2048
  ds_read_b64_tr_b16 a[58:59], v180 offset:2560
  ds_read_b64_tr_b16 a[62:63], v181 offset:2560
  s_waitcnt lgkmcnt(0)
  s_add_u32 m0, s77, 0
  s_add_u32 s76, s75, 139264
  buffer_load_dwordx4 v9, s[44:47], s76 offen  lds
  buffer_load_dwordx4 v12, s[44:47], s76 offen offset:1024  lds
  s_add_u32 m0, s77, 2048
  s_add_u32 s76, s11, 131072
  buffer_load_dwordx4 v9, s[44:47], s76 offen  lds
  buffer_load_dwordx4 v12, s[44:47], s76 offen offset:1024  lds
  ds_read_b128 v[96:99], v200 offset:192
  ds_read_b64_tr_b16 v[100:101], v201 offset:12288
  ds_read_b64_tr_b16 v[102:103], v201 offset:14336
  ds_read_b128 v[104:107], v200 offset:224
  ds_read_b64_tr_b16 v[108:109], v201 offset:13312
  ds_read_b64_tr_b16 v[110:111], v201 offset:15360
  ds_read_b128 v[112:115], v200 offset:256
  ds_read_b64_tr_b16 v[116:117], v201 offset:16384
  ds_read_b64_tr_b16 v[118:119], v201 offset:18432
  ds_read_b128 v[120:123], v200 offset:288
  ds_read_b64_tr_b16 v[124:125], v201 offset:17408
  ds_read_b64_tr_b16 v[126:127], v201 offset:19456
  ds_read_b128 v[128:131], v200 offset:320
  ds_read_b64_tr_b16 v[132:133], v201 offset:20480
  ds_read_b64_tr_b16 v[134:135], v201 offset:22528
  s_waitcnt lgkmcnt(9)
  v_mfma_f32_32x32x16_bf16 v[144:159], v[96:99], v[100:103], v[144:159]
  ds_read_b128 v[136:139], v200 offset:352
  ds_read_b64_tr_b16 v[140:141], v201 offset:21504
  ds_read_b64_tr_b16 v[142:143], v201 offset:23552
  v_mfma_f32_32x32x16_bf16 v[144:159], v[104:107], v[108:111], v[144:159]
  ds_read_b128 v[96:99], v200 offset:384
  ds_read_b64_tr_b16 v[100:101], v201 offset:24576
  ds_read_b64_tr_b16 v[102:103], v201 offset:26624
  s_waitcnt lgkmcnt(9)
  v_mfma_f32_32x32x16_bf16 v[144:159], v[112:115], v[116:119], v[144:159]
  ds_read_b128 v[104:107], v200 offset:416
  ds_read_b64_tr_b16 v[108:109], v201 offset:25600
  ds_read_b64_tr_b16 v[110:111], v201 offset:27648
  v_mfma_f32_32x32x16_bf16 v[144:159], v[120:123], v[124:127], v[144:159]
  ds_read_b128 v[112:115], v200 offset:448
  ds_read_b64_tr_b16 v[116:117], v201 offset:28672
  ds_read_b64_tr_b16 v[118:119], v201 offset:30720
  s_waitcnt lgkmcnt(9)
  v_mfma_f32_32x32x16_bf16 v[144:159], v[128:131], v[132:135], v[144:159]
  ds_read_b128 v[120:123], v200 offset:480
  ds_read_b64_tr_b16 v[124:125], v201 offset:29696
  ds_read_b64_tr_b16 v[126:127], v201 offset:31744
  v_mfma_f32_32x32x16_bf16 v[144:159], v[136:139], v[140:143], v[144:159]
  ds_read_b128 v[128:131], v200 offset:512
  ds_read_b64_tr_b16 v[132:133], v201 offset:32768
  ds_read_b64_tr_b16 v[134:135], v201 offset:34816
  s_waitcnt lgkmcnt(9)
  v_mfma_f32_32x32x16_bf16 v[144:159], v[96:99], v[100:103], v[144:159]
  ds_read_b128 v[136:139], v200 offset:544
  ds_read_b64_tr_b16 v[140:141], v201 offset:33792
  ds_read_b64_tr_b16 v[142:143], v201 offset:35840
  v_mfma_f32_32x32x16_bf16 v[144:159], v[104:107], v[108:111], v[144:159]
  ds_read_b128 v[96:99], v200 offset:576
  ds_read_b64_tr_b16 v[100:101], v201 offset:36864
  ds_read_b64_tr_b16 v[102:103], v201 offset:38912
  s_waitcnt vmcnt(4)
  v_mov_b32 v3, s65
  s_mov_b64 exec, 1
  s_cmp_eq_u32 s67, 0
  s_cbranch_scc1 L_slow_28
  buffer_store_dword v3, off, s[52:55], s26 offset:0
L_back_29:
  s_mov_b64 exec, -1
  s_waitcnt lgkmcnt(9)
  v_mfma_f32_32x32x16_bf16 v[144:159], v[112:115], v[116:119], v[144:159]
  ds_read_b128 v[104:107], v200 offset:608
  ds_read_b64_tr_b16 v[108:109], v201 offset:37888
  ds_read_b64_tr_b16 v[110:111], v201 offset:39936
  v_mfma_f32_32x32x16_bf16 v[144:159], v[120:123], v[124:127], v[144:159]
  ds_read_b128 v[112:115], v200 offset:640
  ds_read_b64_tr_b16 v[116:117], v201 offset:40960
  ds_read_b64_tr_b16 v[118:119], v201 offset:43008
  s_waitcnt lgkmcnt(9)
  v_mfma_f32_32x32x16_bf16 v[144:159], v[128:131], v[132:135], v[144:159]
  ds_read_b128 v[120:123], v200 offset:672
  ds_read_b64_tr_b16 v[124:125], v201 offset:41984
  ds_read_b64_tr_b16 v[126:127], v201 offset:44032
  v_mfma_f32_32x32x16_bf16 v[144:159], v[136:139], v[140:143], v[144:159]
  ds_read_b128 v[128:131], v200 offset:704
  ds_read_b64_tr_b16 v[132:133], v201 offset:45056
  ds_read_b64_tr_b16 v[134:135], v201 offset:47104
  s_waitcnt lgkmcnt(9)
  v_mfma_f32_32x32x16_bf16 v[144:159], v[96:99], v[100:103], v[144:159]
  ds_read_b128 v[136:139], v200 offset:736
  ds_read_b64_tr_b16 v[140:141], v201 offset:46080
  ds_read_b64_tr_b16 v[142:143], v201 offset:48128
  v_mfma_f32_32x32x16_bf16 v[144:159], v[104:107], v[108:111], v[144:159]
  ds_read_b128 v[96:99], v200 offset:768
  ds_read_b64_tr_b16 v[100:101], v201 offset:49152
  ds_read_b64_tr_b16 v[102:103], v201 offset:51200
  s_waitcnt lgkmcnt(9)
  v_mfma_f32_32x32x16_bf16 v[144:159], v[112:115], v[116:119], v[144:159]
  ds_read_b128 v[104:107], v200 offset:800
  ds_read_b64_tr_b16 v[108:109], v201 offset:50176
  ds_read_b64_tr_b16 v[110:111], v201 offset:52224
  s_waitcnt vmcnt(1)
  ds_read_b64_tr_b16 a[64:65], v180 offset:4096
  ds_read_b64_tr_b16 a[68:69], v181 offset:4096
  ds_read_b64_tr_b16 a[72:73], v180 offset:4608
  ds_read_b64_tr_b16 a[76:77], v181 offset:4608
  ds_read_b64_tr_b16 a[66:67], v180 offset:0
  ds_read_b64_tr_b16 a[70:71], v181 offset:0
  ds_read_b64_tr_b16 a[74:75], v180 offset:512
  ds_read_b64_tr_b16 a[78:79], v181 offset:512
  ds_read_b64_tr_b16 a[80:81], v180 offset:2048
  ds_read_b64_tr_b16 a[84:85], v181 offset:2048
  ds_read_b64_tr_b16 a[88:89], v180 offset:2560
  ds_read_b64_tr_b16 a[92:93], v181 offset:2560
  s_waitcnt lgkmcnt(0)
  buffer_load_dword v3, v254, s[52:55], s27 offen offset:0 sc1
  s_add_u32 m0, s77, 4096
  s_add_u32 s76, s11, 139264
  buffer_load_dwordx4 v9, s[44:47], s76 offen  lds
  buffer_load_dwordx4 v12, s[44:47], s76 offen offset:1024  lds
  s_add_u32 m0, s77, 0
  s_add_u32 s76, s75, 262144
  buffer_load_dwordx4 v9, s[44:47], s76 offen  lds
  buffer_load_dwordx4 v12, s[44:47], s76 offen offset:1024  lds
  s_add_u32 m0, s77, 2048
  s_add_u32 s76, s75, 270336
  buffer_load_dwordx4 v9, s[44:47], s76 offen  lds
  buffer_load_dwordx4 v12, s[44:47], s76 offen offset:1024  lds
  v_mfma_f32_32x32x16_bf16 v[144:159], v[120:123], v[124:127], v[144:159]
  ds_read_b128 v[112:115], v200 offset:832
  ds_read_b64_tr_b16 v[116:117], v201 offset:53248
  ds_read_b64_tr_b16 v[118:119], v201 offset:55296
  v_mfma_f32_32x32x16_bf16 v[144:159], v[128:131], v[132:135], v[144:159]
  ds_read_b128 v[120:123], v200 offset:864
  ds_read_b64_tr_b16 v[124:125], v201 offset:54272
  ds_read_b64_tr_b16 v[126:127], v201 offset:56320
  v_mfma_f32_32x32x16_bf16 v[144:159], v[136:139], v[140:143], v[144:159]
  ds_read_b128 v[128:131], v200 offset:896
  ds_read_b64_tr_b16 v[132:133], v201 offset:57344
  ds_read_b64_tr_b16 v[134:135], v201 offset:59392
  v_mfma_f32_32x32x16_bf16 v[144:159], v[96:99], v[100:103], v[144:159]
  ds_read_b128 v[136:139], v200 offset:928
  ds_read_b64_tr_b16 v[140:141], v201 offset:58368
  ds_read_b64_tr_b16 v[142:143], v201 offset:60416
  v_mfma_f32_32x32x16_bf16 v[144:159], v[104:107], v[108:111], v[144:159]
  ds_read_b128 v[96:99], v200 offset:960
  ds_read_b64_tr_b16 v[100:101], v201 offset:61440
  ds_read_b64_tr_b16 v[102:103], v201 offset:63488
  s_waitcnt lgkmcnt(9)
  v_mfma_f32_32x32x16_bf16 v[144:159], v[112:115], v[116:119], v[144:159]
  ds_read_b128 v[104:107], v200 offset:992
  ds_read_b64_tr_b16 v[108:109], v201 offset:62464
  ds_read_b64_tr_b16 v[110:111], v201 offset:64512
  v_mfma_f32_32x32x16_bf16 v[144:159], v[120:123], v[124:127], v[144:159]
  s_waitcnt lgkmcnt(6)
  v_mfma_f32_32x32x16_bf16 v[144:159], v[128:131], v[132:135], v[144:159]
  s_waitcnt vmcnt(6)
  v_cmp_ne_u32 vcc, s65, v3
  s_cbranch_vccnz L_pagain_30
L_pok_32:
  s_add_u32 s4, s70, 0
  buffer_load_dwordx4 v[16:19], v2, s[32:35], s4 offen offset:0 sc1
  buffer_load_dwordx4 v[20:23], v2, s[32:35], s4 offen offset:1024 sc1
  buffer_load_dwordx4 v[24:27], v2, s[32:35], s4 offen offset:2048 sc1
  buffer_load_dwordx4 v[28:31], v2, s[32:35], s4 offen offset:3072 sc1
  s_add_u32 s4, s70, 4096
  buffer_load_dwordx4 v[32:35], v2, s[32:35], s4 offen offset:0 sc1
  buffer_load_dwordx4 v[36:39], v2, s[32:35], s4 offen offset:1024 sc1
  buffer_load_dwordx4 v[40:43], v2, s[32:35], s4 offen offset:2048 sc1
  buffer_load_dwordx4 v[44:47], v2, s[32:35], s4 offen offset:3072 sc1
  s_add_u32 s4, s70, 8192
  buffer_load_dwordx4 v[48:51], v2, s[32:35], s4 offen offset:0 sc1
  buffer_load_dwordx4 v[52:55], v2, s[32:35], s4 offen offset:1024 sc1
  v_mfma_f32_32x32x16_bf16 v[144:159], v[136:139], v[140:143], v[144:159]
  s_waitcnt lgkmcnt(0)
  v_mfma_f32_32x32x16_bf16 v[144:159], v[96:99], v[100:103], v[144:159]
  v_mfma_f32_32x32x16_bf16 v[144:159], v[104:107], v[108:111], v[144:159]
  s_nop 11
  v_cvt_pk_bf16_f32 v164, v145, v144
  v_lshlrev_b32 v165, 16, v164
  v_and_b32 v166, s68, v164
  v_sub_f32 v145, v145, v165
  v_sub_f32 v144, v144, v166
  v_cvt_pk_bf16_f32 v160, v165, v145
  v_cvt_pk_bf16_f32 v161, v165, v166
  v_cvt_pk_bf16_f32 v162, v144, v166
  v_mov_b32 v163, 0
  ds_write_b128 v202, v[160:163]
  ds_read_b64_tr_b16 a[0:1], v13 offset:0
  ds_read_b64_tr_b16 a[2:3], v13 offset:2048
  ds_read_b64_tr_b16 a[4:5], v13 offset:512
  ds_read_b64_tr_b16 a[6:7], v13 offset:2560
  ds_read_b64_tr_b16 a[8:9], v13 offset:1024
  ds_read_b64_tr_b16 a[10:11], v13 offset:3072
  ds_read_b64_tr_b16 a[12:13], v13 offset:1536
  ds_read_b64_tr_b16 a[14:15], v13 offset:3584
  ds_read_b64_tr_b16 a[16:17], v13 offset:4096
  ds_read_b64_tr_b16 a[18:19], v13 offset:6144
  s_waitcnt vmcnt(10)
  ds_read_b64_tr_b16 a[82:83], v180 offset:4096
  ds_read_b64_tr_b16 a[86:87], v181 offset:4096
  ds_read_b64_tr_b16 a[90:91], v180 offset:4608
  ds_read_b64_tr_b16 a[94:95], v181 offset:4608
  ds_read_b64_tr_b16 a[96:97], v180 offset:0
  ds_read_b64_tr_b16 a[100:101], v181 offset:0
  ds_read_b64_tr_b16 a[104:105], v180 offset:512
  ds_read_b64_tr_b16 a[108:109], v181 offset:512
  ds_read_b64_tr_b16 a[98:99], v180 offset:2048
  ds_read_b64_tr_b16 a[102:103], v181 offset:2048
  ds_read_b64_tr_b16 a[106:107], v180 offset:2560
  ds_read_b64_tr_b16 a[110:111], v181 offset:2560
  s_waitcnt lgkmcnt(0)
  s_waitcnt vmcnt(9)
  v_mfma_f32_32x32x16_bf16 v[144:159], a[0:3], v[16:19], 0
  buffer_load_dwordx4 v[56:59], v2, s[32:35], s4 offen offset:2048 sc1
L_pad5:
  s_cbranch_execz L_body
  ds_read_b64_tr_b16 a[20:21], v13 offset:4608
  ds_read_b64_tr_b16 a[22:23], v13 offset:6656
  v_mfma_f32_32x32x16_bf16 v[160:175], a[4:7], v[16:19], 0
  ds_read_b64_tr_b16 a[24:25], v13 offset:5120
  ds_read_b64_tr_b16 a[26:27], v13 offset:7168
  s_waitcnt vmcnt(9)
  v_mfma_f32_32x32x16_bf16 v[144:159], a[8:11], v[20:23], v[144:159]
  buffer_load_dwordx4 v[60:63], v2, s[32:35], s4 offen offset:3072 sc1
  s_add_u32 s4, s70, 12288
  ds_read_b64_tr_b16 a[28:29], v13 offset:5632
  ds_read_b64_tr_b16 a[30:31], v13 offset:7680
  v_mfma_f32_32x32x16_bf16 v[160:175], a[12:15], v[20:23], v[160:175]
  ds_read_b64_tr_b16 a[0:1], v13 offset:8192
  ds_read_b64_tr_b16 a[2:3], v13 offset:10240
  s_waitcnt vmcnt(9) lgkmcnt(6)
  v_mfma_f32_32x32x16_bf16 v[144:159], a[16:19], v[24:27], v[144:159]
  buffer_load_dwordx4 v[64:67], v2, s[32:35], s4 offen offset:0 sc1
  ds_read_b64_tr_b16 a[4:5], v13 offset:8704
  ds_read_b64_tr_b16 a[6:7], v13 offset:10752
  v_mfma_f32_32x32x16_bf16 v[160:175], a[20:23], v[24:27], v[160:175]
  ds_read_b64_tr_b16 a[8:9], v13 offset:9216
  ds_read_b64_tr_b16 a[10:11], v13 offset:11264
  s_waitcnt vmcnt(9) lgkmcnt(6)
  v_mfma_f32_32x32x16_bf16 v[144:159], a[24:27], v[28:31], v[144:159]
  buffer_load_dwordx4 v[68:71], v2, s[32:35], s4 offen offset:1024 sc1
  ds_read_b64_tr_b16 a[12:13], v13 offset:9728
  ds_read_b64_tr_b16 a[14:15], v13 offset:11776
  v_mfma_f32_32x32x16_bf16 v[160:175], a[28:31], v[28:31], v[160:175]
  ds_read_b64_tr_b16 a[16:17], v13 offset:12288
  ds_read_b64_tr_b16 a[18:19], v13 offset:14336
  s_waitcnt vmcnt(9) lgkmcnt(6)
  v_mfma_f32_32x32x16_bf16 v[144:159], a[0:3], v[32:35], v[144:159]
  buffer_load_dwordx4 v[72:75], v2, s[32:35], s4 offen offset:2048 sc1
  ds_read_b64_tr_b16 a[20:21], v13 offset:12800
  ds_read_b64_tr_b16 a[22:23], v13 offset:14848
  v_mfma_f32_32x32x16_bf16 v[160:175], a[4:7], v[32:35], v[160:175]
  buffer_load_dword v204, v179, s[52:55], s69 offen offset:0 sc1
  ds_read_b64_tr_b16 a[24:25], v13 offset:13312
  ds_read_b64_tr_b16 a[26:27], v13 offset:15360
  s_waitcnt vmcnt(10) lgkmcnt(6)
  v_mfma_f32_32x32x16_bf16 v[144:159], a[8:11], v[36:39], v[144:159]
  buffer_load_dwordx4 v[76:79], v2, s[32:35], s4 offen offset:3072 sc1
  s_add_u32 s4, s70, 16384
  ds_read_b64_tr_b16 a[28:29], v13 offset:13824
  ds_read_b64_tr_b16 a[30:31], v13 offset:15872
  v_mfma_f32_32x32x16_bf16 v[160:175], a[12:15], v[36:39], v[160:175]
  buffer_load_dword v205, v179, s[52:55], s69 offen offset:256 sc1
  ds_read_b64_tr_b16 a[0:1], v13 offset:16384
  ds_read_b64_tr_b16 a[2:3], v13 offset:18432
  s_waitcnt vmcnt(11) lgkmcnt(6)
  v_mfma_f32_32x32x16_bf16 v[144:159], a[16:19], v[40:43], v[144:159]
  buffer_load_dwordx4 v[80:83], v2, s[32:35], s4 offen offset:0 sc1
  ds_read_b64_tr_b16 a[4:5], v13 offset:16896
  ds_read_b64_tr_b16 a[6:7], v13 offset:18944
  v_mfma_f32_32x32x16_bf16 v[160:175], a[20:23], v[40:43], v[160:175]
  buffer_load_dword v206, v179, s[52:55], s69 offen offset:512 sc1
  ds_read_b64_tr_b16 a[8:9], v13 offset:17408
  ds_read_b64_tr_b16 a[10:11], v13 offset:19456
  s_waitcnt vmcnt(12) lgkmcnt(6)
  v_mfma_f32_32x32x16_bf16 v[144:159], a[24:27], v[44:47], v[144:159]
  buffer_load_dwordx4 v[84:87], v2, s[32:35], s4 offen offset:1024 sc1
  ds_read_b64_tr_b16 a[12:13], v13 offset:17920
  ds_read_b64_tr_b16 a[14:15], v13 offset:19968
  v_mfma_f32_32x32x16_bf16 v[160:175], a[28:31], v[44:47], v[160:175]
  buffer_load_dword v207, v179, s[52:55], s69 offen offset:768 sc1
  ds_read_b64_tr_b16 a[16:17], v13 offset:20480
  ds_read_b64_tr_b16 a[18:19], v13 offset:22528
  s_waitcnt vmcnt(13) lgkmcnt(6)
  v_mfma_f32_32x32x16_bf16 v[144:159], a[0:3], v[48:51], v[144:159]
  buffer_load_dwordx4 v[88:91], v2, s[32:35], s4 offen offset:2048 sc1
  ds_read_b64_tr_b16 a[20:21], v13 offset:20992
  ds_read_b64_tr_b16 a[22:23], v13 offset:23040
  v_mfma_f32_32x32x16_bf16 v[160:175], a[4:7], v[48:51], v[160:175]
  buffer_load_dword v208, v179, s[52:55], s69 offen offset:1024 sc1
  ds_read_b64_tr_b16 a[24:25], v13 offset:21504
  ds_read_b64_tr_b16 a[26:27], v13 offset:23552
  s_waitcnt vmcnt(14) lgkmcnt(6)
  v_mfma_f32_32x32x16_bf16 v[144:159], a[8:11], v[52:55], v[144:159]
  buffer_load_dwordx4 v[92:95], v2, s[32:35], s4 offen offset:3072 sc1
  s_add_u32 s4, s70, 20480
  ds_read_b64_tr_b16 a[28:29], v13 offset:22016
  ds_read_b64_tr_b16 a[30:31], v13 offset:24064
  v_mfma_f32_32x32x16_bf16 v[160:175], a[12:15], v[52:55], v[160:175]
  buffer_load_dword v209, v179, s[52:55], s69 offen offset:1280 sc1
  ds_read_b64_tr_b16 a[0:1], v13 offset:24576
  ds_read_b64_tr_b16 a[2:3], v13 offset:26624
  s_waitcnt vmcnt(15) lgkmcnt(6)
  v_mfma_f32_32x32x16_bf16 v[144:159], a[16:19], v[56:59], v[144:159]
  buffer_load_dwordx4 v[96:99], v2, s[32:35], s4 offen offset:0 sc1
  ds_read_b64_tr_b16 a[4:5], v13 offset:25088
  ds_read_b64_tr_b16 a[6:7], v13 offset:27136
  v_mfma_f32_32x32x16_bf16 v[160:175], a[20:23], v[56:59], v[160:175]
  buffer_load_dword v210, v179, s[52:55], s69 offen offset:1536 sc1
  ds_read_b64_tr_b16 a[8:9], v13 offset:25600
  ds_read_b64_tr_b16 a[10:11], v13 offset:27648
  s_waitcnt vmcnt(16) lgkmcnt(6)
  v_mfma_f32_32x32x16_bf16 v[144:159], a[24:27], v[60:63], v[144:159]
  buffer_load_dwordx4 v[100:103], v2, s[32:35], s4 offen offset:1024 sc1
  ds_read_b64_tr_b16 a[12:13], v13 offset:26112
  ds_read_b64_tr_b16 a[14:15], v13 offset:28160
  v_mfma_f32_32x32x16_bf16 v[160:175], a[28:31], v[60:63], v[160:175]
  buffer_load_dword v211, v179, s[52:55], s69 offen offset:1792 sc1
  ds_read_b64_tr_b16 a[16:17], v13 offset:28672
  ds_read_b64_tr_b16 a[18:19], v13 offset:30720
  s_waitcnt vmcnt(17) lgkmcnt(6)
  v_mfma_f32_32x32x16_bf16 v[144:159], a[0:3], v[64:67], v[144:159]
  buffer_load_dwordx4 v[104:107], v2, s[32:35], s4 offen offset:2048 sc1
  ds_read_b64_tr_b16 a[20:21], v13 offset:29184
  ds_read_b64_tr_b16 a[22:23], v13 offset:31232
  v_mfma_f32_32x32x16_bf16 v[160:175], a[4:7], v[64:67], v[160:175]
  ds_read_b64_tr_b16 a[24:25], v13 offset:29696
  ds_read_b64_tr_b16 a[26:27], v13 offset:31744
  s_waitcnt vmcnt(17) lgkmcnt(6)
  v_mfma_f32_32x32x16_bf16 v[144:159], a[8:11], v[68:71], v[144:159]
  buffer_load_dwordx4 v[108:111], v2, s[32:35], s4 offen offset:3072 sc1
  s_add_u32 s4, s70, 24576
  ds_read_b64_tr_b16 a[28:29], v13 offset:30208
  ds_read_b64_tr_b16 a[30:31], v13 offset:32256
  v_mfma_f32_32x32x16_bf16 v[160:175], a[12:15], v[68:71], v[160:175]
  ds_read_b64_tr_b16 a[0:1], v13 offset:32768
  ds_read_b64_tr_b16 a[2:3], v13 offset:34816
  s_waitcnt vmcnt(17) lgkmcnt(6)
  v_mfma_f32_32x32x16_bf16 v[144:159], a[16:19], v[72:75], v[144:159]
  buffer_load_dwordx4 v[112:115], v2, s[32:35], s4 offen offset:0 sc1
  ds_read_b64_tr_b16 a[4:5], v13 offset:33280
  ds_read_b64_tr_b16 a[6:7], v13 offset:35328
  v_mfma_f32_32x32x16_bf16 v[160:175], a[20:23], v[72:75], v[160:175]
  ds_read_b64_tr_b16 a[8:9], v13 offset:33792
  ds_read_b64_tr_b16 a[10:11], v13 offset:35840
  s_waitcnt vmcnt(16) lgkmcnt(6)
  v_mfma_f32_32x32x16_bf16 v[144:159], a[24:27], v[76:79], v[144:159]
  buffer_load_dwordx4 v[116:119], v2, s[32:35], s4 offen offset:1024 sc1
  ds_read_b64_tr_b16 a[12:13], v13 offset:34304
  ds_read_b64_tr_b16 a[14:15], v13 offset:36352
  v_mfma_f32_32x32x16_bf16 v[160:175], a[28:31], v[76:79], v[160:175]
  ds_read_b64_tr_b16 a[16:17], v13 offset:36864
  ds_read_b64_tr_b16 a[18:19], v13 offset:38912
  s_waitcnt vmcnt(15) lgkmcnt(6)
  v_mfma_f32_32x32x16_bf16 v[144:159], a[0:3], v[80:83], v[144:159]
  buffer_load_dwordx4 v[120:123], v2, s[32:35], s4 offen offset:2048 sc1
  ds_read_b64_tr_b16 a[20:21], v13 offset:37376
  ds_read_b64_tr_b16 a[22:23], v13 offset:39424
  v_mfma_f32_32x32x16_bf16 v[160:175], a[4:7], v[80:83], v[160:175]
  ds_read_b64_tr_b16 a[24:25], v13 offset:37888
  ds_read_b64_tr_b16 a[26:27], v13 offset:39936
  s_waitcnt vmcnt(14) lgkmcnt(6)
  v_mfma_f32_32x32x16_bf16 v[144:159], a[8:11], v[84:87], v[144:159]
  buffer_load_dwordx4 v[124:127], v2, s[32:35], s4 offen offset:3072 sc1
  s_add_u32 s4, s70, 28672
  ds_read_b64_tr_b16 a[28:29], v13 offset:38400
  ds_read_b64_tr_b16 a[30:31], v13 offset:40448
  v_mfma_f32_32x32x16_bf16 v[160:175], a[12:15], v[84:87], v[160:175]
  ds_read_b64_tr_b16 a[0:1], v13 offset:40960
  ds_read_b64_tr_b16 a[2:3], v13 offset:43008
  s_waitcnt vmcnt(13) lgkmcnt(6)
  v_mfma_f32_32x32x16_bf16 v[144:159], a[16:19], v[88:91], v[144:159]
  buffer_load_dwordx4 v[128:131], v2, s[32:35], s4 offen offset:0 sc1
  ds_read_b64_tr_b16 a[4:5], v13 offset:41472
  ds_read_b64_tr_b16 a[6:7], v13 offset:43520
  s_waitcnt vmcnt(7)
  v_mfma_f32_32x32x16_bf16 v[160:175], a[20:23], v[88:91], v[160:175]
  ds_read_b64_tr_b16 a[8:9], v13 offset:41984
  ds_read_b64_tr_b16 a[10:11], v13 offset:44032
  v_add_f32 v204, v204, v208
  v_add_f32 v205, v205, v209
  s_waitcnt lgkmcnt(6)
  v_mfma_f32_32x32x16_bf16 v[144:159], a[24:27], v[92:95], v[144:159]
  buffer_load_dwordx4 v[132:135], v2, s[32:35], s4 offen offset:1024 sc1
  ds_read_b64_tr_b16 a[12:13], v13 offset:42496
  ds_read_b64_tr_b16 a[14:15], v13 offset:44544
  v_add_f32 v206, v206, v210
  v_mfma_f32_32x32x16_bf16 v[160:175], a[28:31], v[92:95], v[160:175]
  ds_read_b64_tr_b16 a[16:17], v13 offset:45056
  ds_read_b64_tr_b16 a[18:19], v13 offset:47104
  v_add_f32 v207, v207, v211
  v_add_f32 v204, v204, v206
  s_waitcnt lgkmcnt(6)
  v_mfma_f32_32x32x16_bf16 v[144:159], a[0:3], v[96:99], v[144:159]
  buffer_load_dwordx4 v[136:139], v2, s[32:35], s4 offen offset:2048 sc1
  ds_read_b64_tr_b16 a[20:21], v13 offset:45568
  ds_read_b64_tr_b16 a[22:23], v13 offset:47616
  v_add_f32 v205, v205, v207
  v_mfma_f32_32x32x16_bf16 v[160:175], a[4:7], v[96:99], v[160:175]
  ds_read_b64_tr_b16 a[24:25], v13 offset:46080
  ds_read_b64_tr_b16 a[26:27], v13 offset:48128
  v_add_f32 v204, v204, v205
  v_mov_b32 v205, v204
  s_waitcnt lgkmcnt(6)
  v_mfma_f32_32x32x16_bf16 v[144:159], a[8:11], v[100:103], v[144:159]
  buffer_load_dwordx4 v[140:143], v2, s[32:35], s4 offen offset:3072 sc1
  ds_read_b64_tr_b16 a[28:29], v13 offset:46592
  ds_read_b64_tr_b16 a[30:31], v13 offset:48640
  s_lshl_b32 s3, s60, 7
  v_mfma_f32_32x32x16_bf16 v[160:175], a[12:15], v[100:103], v[160:175]
  s_add_u32 m0, s77, 4096
  s_add_u32 s76, s11, 262144
  buffer_load_dwordx4 v9, s[44:47], s76 offen  lds
  ds_read_b64_tr_b16 a[0:1], v13 offset:49152
  ds_read_b64_tr_b16 a[2:3], v13 offset:51200
  s_waitcnt vmcnt(10) lgkmcnt(6)
  v_mfma_f32_32x32x16_bf16 v[144:159], a[16:19], v[104:107], v[144:159]
  ds_read_b64_tr_b16 a[4:5], v13 offset:49664
  ds_read_b64_tr_b16 a[6:7], v13 offset:51712
  s_add_u32 s3, s3, 160256
  v_add_u32 v4, s3, v252
  v_mfma_f32_32x32x16_bf16 v[160:175], a[20:23], v[104:107], v[160:175]
  buffer_load_dwordx4 v12, s[44:47], s76 offen offset:1024  lds
  ds_read_b64_tr_b16 a[8:9], v13 offset:50176
  ds_read_b64_tr_b16 a[10:11], v13 offset:52224
  s_waitcnt vmcnt(10) lgkmcnt(6)
  v_mfma_f32_32x32x16_bf16 v[144:159], a[24:27], v[108:111], v[144:159]
  ds_read_b64_tr_b16 a[12:13], v13 offset:50688
  ds_read_b64_tr_b16 a[14:15], v13 offset:52736
  v_permlane32_swap_b32 v204, v205
  v_mul_f32 v204, 0xbb000000, v204
  v_mfma_f32_32x32x16_bf16 v[160:175], a[28:31], v[108:111], v[160:175]
  s_add_u32 m0, s77, 0
  s_add_u32 s76, s11, 270336
  buffer_load_dwordx4 v9, s[44:47], s76 offen  lds
  ds_read_b64_tr_b16 a[16:17], v13 offset:53248
  ds_read_b64_tr_b16 a[18:19], v13 offset:55296
  s_waitcnt vmcnt(10) lgkmcnt(6)
  v_mfma_f32_32x32x16_bf16 v[144:159], a[0:3], v[112:115], v[144:159]
  ds_read_b64_tr_b16 a[20:21], v13 offset:53760
  ds_read_b64_tr_b16 a[22:23], v13 offset:55808
  v_mul_f32 v205, 0x3b000000, v205
  v_fma_f32 v205, -v204, v204, v205
  v_max_f32 v205, 0, v205
  v_mfma_f32_32x32x16_bf16 v[160:175], a[4:7], v[112:115], v[160:175]
  buffer_load_dwordx4 v12, s[44:47], s76 offen offset:1024  lds
  ds_read_b64_tr_b16 a[24:25], v13 offset:54272
  ds_read_b64_tr_b16 a[26:27], v13 offset:56320
  s_waitcnt vmcnt(10) lgkmcnt(6)
  s_barrier
  v_mfma_f32_32x32x16_bf16 v[144:159], a[8:11], v[116:119], v[144:159]
  ds_read_b64_tr_b16 a[28:29], v13 offset:54784
  ds_read_b64_tr_b16 a[30:31], v13 offset:56832
  v_add_f32 v206, 0x3727c5ac, v205
  v_sqrt_f32 v205, v206
  v_mfma_f32_32x32x16_bf16 v[160:175], a[12:15], v[116:119], v[160:175]
  s_add_u32 m0, s77, 2048
  s_add_u32 s76, s75, 393216
  buffer_load_dwordx4 v9, s[44:47], s76 offen  lds
  ds_read_b64_tr_b16 a[0:1], v13 offset:57344
  ds_read_b64_tr_b16 a[2:3], v13 offset:59392
  s_waitcnt vmcnt(10) lgkmcnt(6)
  v_mfma_f32_32x32x16_bf16 v[144:159], a[16:19], v[120:123], v[144:159]
  ds_read_b64_tr_b16 a[4:5], v13 offset:57856
  ds_read_b64_tr_b16 a[6:7], v13 offset:59904
  v_rsq_f32 v206, v206
  v_cmp_gt_u32 vcc, 32, v1
  v_mfma_f32_32x32x16_bf16 v[160:175], a[20:23], v[120:123], v[160:175]
  buffer_load_dwordx4 v12, s[44:47], s76 offen offset:1024  lds
  ds_read_b64_tr_b16 a[8:9], v13 offset:58368
  ds_read_b64_tr_b16 a[10:11], v13 offset:60416
  s_waitcnt vmcnt(10) lgkmcnt(6)
  v_mfma_f32_32x32x16_bf16 v[144:159], a[24:27], v[124:127], v[144:159]
  ds_read_b64_tr_b16 a[12:13], v13 offset:58880
  ds_read_b64_tr_b16 a[14:15], v13 offset:60928
  ds_write_b32 v4, v206
  v_cndmask_b32 v204, 0, v204, vcc
  v_mfma_f32_32x32x16_bf16 v[160:175], a[28:31], v[124:127], v[160:175]
  s_add_u32 m0, s13, 0
  s_add_u32 s76, s75, 401408
  buffer_load_dwordx4 v9, s[44:47], s76 offen  lds
  ds_read_b64_tr_b16 a[16:17], v13 offset:61440
  ds_read_b64_tr_b16 a[18:19], v13 offset:63488
  s_waitcnt vmcnt(10) lgkmcnt(7)
  v_mfma_f32_32x32x16_bf16 v[144:159], a[0:3], v[128:131], v[144:159]
  ds_read_b64_tr_b16 a[20:21], v13 offset:61952
  ds_read_b64_tr_b16 a[22:23], v13 offset:64000
  v_cndmask_b32 v205, 0, v205, vcc
  v_cvt_pk_bf16_f32 v208, v204, v205
  v_lshlrev_b32 v209, 16, v208
  v_mfma_f32_32x32x16_bf16 v[160:175], a[4:7], v[128:131], v[160:175]
  buffer_load_dwordx4 v12, s[44:47], s76 offen offset:1024  lds
  ds_read_b64_tr_b16 a[24:25], v13 offset:62464
  ds_read_b64_tr_b16 a[26:27], v13 offset:64512
  s_waitcnt vmcnt(10) lgkmcnt(7)
  v_mfma_f32_32x32x16_bf16 v[144:159], a[8:11], v[132:135], v[144:159]
  ds_read_b64_tr_b16 a[28:29], v13 offset:62976
  ds_read_b64_tr_b16 a[30:31], v13 offset:65024
  v_and_b32 v210, s68, v208
  v_sub_f32 v204, v204, v209
  v_sub_f32 v205, v205, v210
  v_mfma_f32_32x32x16_bf16 v[160:175], a[12:15], v[132:135], v[160:175]
  s_add_u32 m0, s13, 8192
  s_add_u32 s76, s10, 65536
  buffer_load_dwordx4 v9, s[44:47], s76 offen  lds
  ds_read_b128 a[0:3], v248 offset:0
  s_waitcnt vmcnt(10) lgkmcnt(5)
  v_mfma_f32_32x32x16_bf16 v[144:159], a[16:19], v[136:139], v[144:159]
  ds_read_b128 a[4:7], v248 offset:512
  v_cvt_pk_bf16_f32 v232, v209, v209
  v_cvt_pk_bf16_f32 v233, v204, v210
  v_cvt_pk_bf16_f32 v234, v210, v205
  v_mov_b32 v235, 0
  v_mfma_f32_32x32x16_bf16 v[160:175], a[20:23], v[136:139], v[160:175]
  buffer_load_dwordx4 v12, s[44:47], s76 offen offset:1024  lds
  ds_read_b64_tr_b16 a[8:9], v14 offset:0
  ds_read_b64_tr_b16 a[10:11], v14 offset:2048
  s_waitcnt vmcnt(10) lgkmcnt(4)
  v_mfma_f32_32x32x16_bf16 v[144:159], a[24:27], v[140:143], v[144:159]
  ds_read_b64_tr_b16 a[12:13], v14 offset:1024
  ds_read_b64_tr_b16 a[14:15], v14 offset:3072
  v_mfma_f32_32x32x16_bf16 v[160:175], a[28:31], v[140:143], v[160:175]
  s_add_u32 m0, s13, 16384
  s_add_u32 s76, s10, 73728
  buffer_load_dwordx4 v9, s[44:47], s76 offen  lds
  ds_read_b64_tr_b16 a[16:17], v14 offset:4096
  ds_read_b64_tr_b16 a[18:19], v14 offset:6144
  s_waitcnt lgkmcnt(6)
  v_mfma_f32_32x32x16_bf16 v[144:159], a[0:3], v[232:235], v[144:159]
  ds_read_b64_tr_b16 a[20:21], v14 offset:5120
  ds_read_b64_tr_b16 a[22:23], v14 offset:7168
  v_mfma_f32_32x32x16_bf16 v[160:175], a[4:7], v[232:235], v[160:175]
  buffer_load_dwordx4 v12, s[44:47], s76 offen offset:1024  lds
  ds_read_b64_tr_b16 a[24:25], v14 offset:8192
  ds_read_b64_tr_b16 a[26:27], v14 offset:10240
  s_waitcnt lgkmcnt(6)
  s_barrier
  v_mfma_f32_32x32x16_bf16 v[200:215], a[8:11], v[16:19], 0
  ds_read_b64_tr_b16 a[28:29], v14 offset:9216
  ds_read_b64_tr_b16 a[30:31], v14 offset:11264
  s_xor_b32 s3, s60, 3
  s_mul_i32 s3, s3, 57344
  s_add_u32 s8, s3, s74
  v_mfma_f32_32x32x16_bf16 v[200:215], a[12:15], v[20:23], v[200:215]
  ds_read_b64_tr_b16 a[0:1], v14 offset:12288
  ds_read_b64_tr_b16 a[2:3], v14 offset:14336
  s_xor_b32 s3, s60, 2
  s_mul_i32 s3, s3, 57344
  s_waitcnt lgkmcnt(6)
  v_mfma_f32_32x32x16_bf16 v[200:215], a[16:19], v[24:27], v[200:215]
  ds_read_b64_tr_b16 a[4:5], v14 offset:13312
  ds_read_b64_tr_b16 a[6:7], v14 offset:15360
  v_cvt_pk_bf16_f32 v144, v144, v145
  v_cvt_pk_bf16_f32 v145, v146, v147
  v_cvt_pk_bf16_f32 v146, v148, v149
  v_cvt_pk_bf16_f32 v147, v150, v151
  v_mfma_f32_32x32x16_bf16 v[200:215], a[20:23], v[28:31], v[200:215]
  ds_read_b64_tr_b16 a[8:9], v14 offset:16384
  ds_read_b64_tr_b16 a[10:11], v14 offset:18432
  v_pk_max_i16 v144, v144, 0
  v_pk_max_i16 v145, v145, 0
  v_pk_max_i16 v146, v146, 0
  v_pk_max_i16 v147, v147, 0
  s_waitcnt lgkmcnt(6)
  v_mfma_f32_32x32x16_bf16 v[200:215], a[24:27], v[32:35], v[200:215]
  buffer_store_dwordx4 v[144:147], v253, s[32:35], s71 offen offset:0 sc1
  ds_read_b64_tr_b16 a[12:13], v14 offset:17408
  ds_read_b64_tr_b16 a[14:15], v14 offset:19456
  v_cvt_pk_bf16_f32 v148, v152, v153
  v_cvt_pk_bf16_f32 v149, v154, v155
  v_cvt_pk_bf16_f32 v150, v156, v157
  v_cvt_pk_bf16_f32 v151, v158, v159
  v_mfma_f32_32x32x16_bf16 v[200:215], a[28:31], v[36:39], v[200:215]
  ds_read_b64_tr_b16 a[16:17], v14 offset:20480
  ds_read_b64_tr_b16 a[18:19], v14 offset:22528
  v_pk_max_i16 v148, v148, 0
  v_pk_max_i16 v149, v149, 0
  v_pk_max_i16 v150, v150, 0
  v_pk_max_i16 v151, v151, 0
  s_waitcnt lgkmcnt(6)
  v_mfma_f32_32x32x16_bf16 v[200:215], a[0:3], v[40:43], v[200:215]
  buffer_store_dwordx4 v[148:151], v253, s[32:35], s71 offen offset:512 sc1
  ds_read_b64_tr_b16 a[20:21], v14 offset:21504
  ds_read_b64_tr_b16 a[22:23], v14 offset:23552
  v_cvt_pk_bf16_f32 v160, v160, v161
  v_cvt_pk_bf16_f32 v161, v162, v163
  v_cvt_pk_bf16_f32 v162, v164, v165
  v_cvt_pk_bf16_f32 v163, v166, v167
  v_mfma_f32_32x32x16_bf16 v[200:215], a[4:7], v[44:47], v[200:215]
  ds_read_b64_tr_b16 a[24:25], v14 offset:24576
  ds_read_b64_tr_b16 a[26:27], v14 offset:26624
  v_pk_max_i16 v160, v160, 0
  v_pk_max_i16 v161, v161, 0
  v_pk_max_i16 v162, v162, 0
  v_pk_max_i16 v163, v163, 0
  s_waitcnt lgkmcnt(6)
  v_mfma_f32_32x32x16_bf16 v[200:215], a[8:11], v[48:51], v[200:215]
  buffer_store_dwordx4 v[160:163], v253, s[32:35], s71 offen offset:1024 sc1
  ds_read_b64_tr_b16 a[28:29], v14 offset:25600
  ds_read_b64_tr_b16 a[30:31], v14 offset:27648
  v_cvt_pk_bf16_f32 v164, v168, v169
  v_cvt_pk_bf16_f32 v165, v170, v171
  v_cvt_pk_bf16_f32 v166, v172, v173
  v_cvt_pk_bf16_f32 v167, v174, v175
  v_mfma_f32_32x32x16_bf16 v[200:215], a[12:15], v[52:55], v[200:215]
  ds_read_b64_tr_b16 a[0:1], v14 offset:28672
  ds_read_b64_tr_b16 a[2:3], v14 offset:30720
  v_pk_max_i16 v164, v164, 0
  v_pk_max_i16 v165, v165, 0
  v_pk_max_i16 v166, v166, 0
  v_pk_max_i16 v167, v167, 0
  s_waitcnt lgkmcnt(6)
  v_mfma_f32_32x32x16_bf16 v[200:215], a[16:19], v[56:59], v[200:215]
  buffer_store_dwordx4 v[164:167], v253, s[32:35], s71 offen offset:1536 sc1
  ds_read_b64_tr_b16 a[4:5], v14 offset:29696
  ds_read_b64_tr_b16 a[6:7], v14 offset:31744
  s_waitcnt vmcnt(12)
  v_mfma_f32_32x32x16_bf16 v[200:215], a[20:23], v[60:63], v[200:215]
  ds_read_b64_tr_b16 a[8:9], v14 offset:32768
  ds_read_b64_tr_b16 a[10:11], v14 offset:34816
  ds_read_b64_tr_b16 a[112:113], v180 offset:4096
  s_waitcnt lgkmcnt(7)
  v_mfma_f32_32x32x16_bf16 v[200:215], a[24:27], v[64:67], v[200:215]
  ds_read_b64_tr_b16 a[12:13], v14 offset:33792
  ds_read_b64_tr_b16 a[14:15], v14 offset:35840
  ds_read_b64_tr_b16 a[116:117], v181 offset:4096
  s_add_u32 s7, s3, s74
  v_mfma_f32_32x32x16_bf16 v[200:215], a[28:31], v[68:71], v[200:215]
  ds_read_b64_tr_b16 a[16:17], v14 offset:36864
  ds_read_b64_tr_b16 a[18:19], v14 offset:38912
  ds_read_b64_tr_b16 a[120:121], v180 offset:4608
  s_waitcnt lgkmcnt(9)
  v_mfma_f32_32x32x16_bf16 v[200:215], a[0:3], v[72:75], v[200:215]
  ds_read_b64_tr_b16 a[20:21], v14 offset:37888
  ds_read_b64_tr_b16 a[22:23], v14 offset:39936
  ds_read_b64_tr_b16 a[124:125], v181 offset:4608
  s_xor_b32 s3, s60, 1
  v_mfma_f32_32x32x16_bf16 v[200:215], a[4:7], v[76:79], v[200:215]
  ds_read_b64_tr_b16 a[24:25], v14 offset:40960
  ds_read_b64_tr_b16 a[26:27], v14 offset:43008
  ds_read_b64_tr_b16 a[114:115], v180 offset:0
  s_waitcnt lgkmcnt(10)
  v_mfma_f32_32x32x16_bf16 v[200:215], a[8:11], v[80:83], v[200:215]
  ds_read_b64_tr_b16 a[28:29], v14 offset:41984
  ds_read_b64_tr_b16 a[30:31], v14 offset:44032
  ds_read_b64_tr_b16 a[118:119], v181 offset:0
  s_mul_i32 s3, s3, 57344
  v_mfma_f32_32x32x16_bf16 v[200:215], a[12:15], v[84:87], v[200:215]
  ds_read_b64_tr_b16 a[0:1], v14 offset:45056
  ds_read_b64_tr_b16 a[2:3], v14 offset:47104
  ds_read_b64_tr_b16 a[122:123], v180 offset:512
  s_waitcnt lgkmcnt(10)
  v_mfma_f32_32x32x16_bf16 v[200:215], a[16:19], v[88:91], v[200:215]
  ds_read_b64_tr_b16 a[4:5], v14 offset:46080
  ds_read_b64_tr_b16 a[6:7], v14 offset:48128
  ds_read_b64_tr_b16 a[126:127], v181 offset:512
  s_waitcnt lgkmcnt(0)
  v_mfma_f32_32x32x16_bf16 v[200:215], a[20:23], v[92:95], v[200:215]
  ds_read_b64_tr_b16 a[8:9], v14 offset:49152
  ds_read_b64_tr_b16 a[10:11], v14 offset:51200
  s_waitcnt vmcnt(8)
  ds_read_b64_tr_b16 a[128:129], v180 offset:2048
  v_mfma_f32_32x32x16_bf16 v[200:215], a[24:27], v[96:99], v[200:215]
  s_add_u32 m0, s13, 24576
  s_add_u32 s76, s10, 196608
  buffer_load_dwordx4 v9, s[44:47], s76 offen  lds
  ds_read_b64_tr_b16 a[12:13], v14 offset:50176
  ds_read_b64_tr_b16 a[14:15], v14 offset:52224
  v_mfma_f32_32x32x16_bf16 v[200:215], a[28:31], v[100:103], v[200:215]
  ds_read_b64_tr_b16 a[16:17], v14 offset:53248
  ds_read_b64_tr_b16 a[18:19], v14 offset:55296
  ds_read_b64_tr_b16 a[132:133], v181 offset:2048
  v_mfma_f32_32x32x16_bf16 v[200:215], a[0:3], v[104:107], v[200:215]
  buffer_load_dwordx4 v12, s[44:47], s76 offen offset:1024  lds
  ds_read_b64_tr_b16 a[20:21], v14 offset:54272
  ds_read_b64_tr_b16 a[22:23], v14 offset:56320
  s_add_u32 s6, s3, s74
  v_mfma_f32_32x32x16_bf16 v[200:215], a[4:7], v[108:111], v[200:215]
  ds_read_b64_tr_b16 a[24:25], v14 offset:57344
  ds_read_b64_tr_b16 a[26:27], v14 offset:59392
  ds_read_b64_tr_b16 a[136:137], v180 offset:2560
  s_waitcnt lgkmcnt(8)
  v_mfma_f32_32x32x16_bf16 v[200:215], a[8:11], v[112:115], v[200:215]
  s_add_u32 m0, s13, 32768
  s_add_u32 s76, s10, 204800
  buffer_load_dwordx4 v9, s[44:47], s76 offen  lds
  ds_read_b64_tr_b16 a[28:29], v14 offset:58368
  ds_read_b64_tr_b16 a[30:31], v14 offset:60416
  v_mfma_f32_32x32x16_bf16 v[200:215], a[12:15], v[116:119], v[200:215]
  ds_read_b64_tr_b16 a[0:1], v14 offset:61440
  ds_read_b64_tr_b16 a[2:3], v14 offset:63488
  ds_read_b64_tr_b16 a[140:141], v181 offset:2560
  s_waitcnt lgkmcnt(8)
  v_mfma_f32_32x32x16_bf16 v[200:215], a[16:19], v[120:123], v[200:215]
  buffer_load_dwordx4 v12, s[44:47], s76 offen offset:1024  lds
  ds_read_b64_tr_b16 a[4:5], v14 offset:62464
  ds_read_b64_tr_b16 a[6:7], v14 offset:64512
  s_xor_b32 s3, s60, 0
  v_mfma_f32_32x32x16_bf16 v[200:215], a[20:23], v[124:127], v[200:215]
  ds_read_b128 a[8:11], v248 offset:1024
  ds_read_b64_tr_b16 a[130:131], v182 offset:0
  ds_read_b64_tr_b16 a[134:135], v183 offset:0
  s_waitcnt lgkmcnt(8)
  v_mfma_f32_32x32x16_bf16 v[200:215], a[24:27], v[128:131], v[200:215]
  s_add_u32 m0, s13, 40960
  s_add_u32 s76, s10, 327680
  buffer_load_dwordx4 v9, s[44:47], s76 offen  lds
  ds_read_b64_tr_b16 a[12:13], v14 offset:512
  ds_read_b64_tr_b16 a[14:15], v14 offset:2560
  v_mfma_f32_32x32x16_bf16 v[200:215], a[28:31], v[132:135], v[200:215]
  ds_read_b64_tr_b16 a[16:17], v14 offset:1536
  ds_read_b64_tr_b16 a[18:19], v14 offset:3584
  ds_read_b64_tr_b16 a[138:139], v182 offset:512
  s_waitcnt lgkmcnt(8)
  v_mfma_f32_32x32x16_bf16 v[200:215], a[0:3], v[136:139], v[200:215]
  buffer_load_dwordx4 v12, s[44:47], s76 offen offset:1024  lds
  ds_read_b64_tr_b16 a[20:21], v14 offset:4608
  ds_read_b64_tr_b16 a[22:23], v14 offset:6656
  s_mul_i32 s3, s3, 57344
  s_waitcnt vmcnt(6)
  v_mov_b32 v3, s65
  s_mov_b64 exec, 1
  s_cmp_eq_u32 s67, 0
  s_cbranch_scc1 L_slow_33
  buffer_store_dword v3, off, s[52:55], s72 offset:0
L_back_34:
  s_mov_b64 exec, -1
  v_mfma_f32_32x32x16_bf16 v[200:215], a[4:7], v[140:143], v[200:215]
  s_add_u32 m0, s13, 49152
  s_add_u32 s76, s10, 335872
  buffer_load_dwordx4 v9, s[44:47], s76 offen  lds
  ds_read_b64_tr_b16 a[24:25], v14 offset:5632
  ds_read_b64_tr_b16 a[26:27], v14 offset:7680
  s_waitcnt lgkmcnt(7)
  v_mfma_f32_32x32x16_bf16 v[200:215], a[8:11], v[232:235], v[200:215]
  ds_read_b64_tr_b16 a[28:29], v14 offset:8704
  ds_read_b64_tr_b16 a[30:31], v14 offset:10752
  ds_read_b64_tr_b16 a[142:143], v183 offset:512
  s_waitcnt lgkmcnt(0)
  v_mfma_f32_32x32x16_bf16 v[216:231], a[12:15], v[16:19], 0
  buffer_load_dwordx4 v12, s[44:47], s76 offen offset:1024  lds
  ds_read_b64_tr_b16 a[0:1], v14 offset:9728
  ds_read_b64_tr_b16 a[2:3], v14 offset:11776
  v_mfma_f32_32x32x16_bf16 v[216:231], a[16:19], v[20:23], v[216:231]
  ds_read_b64_tr_b16 a[4:5], v14 offset:12800
  ds_read_b64_tr_b16 a[6:7], v14 offset:14848
  ds_read_b64_tr_b16 a[144:145], v182 offset:8192
  s_add_u32 s5, s3, s74
  v_mfma_f32_32x32x16_bf16 v[216:231], a[20:23], v[24:27], v[216:231]
  s_add_u32 m0, s13, 57344
  s_add_u32 s76, s12, 65536
  buffer_load_dwordx4 v9, s[44:47], s76 offen  lds
  ds_read_b64_tr_b16 a[8:9], v14 offset:13824
  ds_read_b64_tr_b16 a[10:11], v14 offset:15872
  v_cvt_pk_bf16_f32 v200, v200, v201
  v_cvt_pk_bf16_f32 v201, v202, v203
  v_cvt_pk_bf16_f32 v202, v204, v205
  v_cvt_pk_bf16_f32 v203, v206, v207
  v_mfma_f32_32x32x16_bf16 v[216:231], a[24:27], v[28:31], v[216:231]
  ds_read_b64_tr_b16 a[12:13], v14 offset:16896
  ds_read_b64_tr_b16 a[14:15], v14 offset:18944
  v_pk_max_i16 v200, v200, 0
  v_pk_max_i16 v201, v201, 0
  v_pk_max_i16 v202, v202, 0
  v_pk_max_i16 v203, v203, 0
  v_mfma_f32_32x32x16_bf16 v[216:231], a[28:31], v[32:35], v[216:231]
  buffer_store_dwordx4 v[200:203], v253, s[32:35], s71 offen offset:2048 sc1
  ds_read_b64_tr_b16 a[16:17], v14 offset:17920
  ds_read_b64_tr_b16 a[18:19], v14 offset:19968
  v_cvt_pk_bf16_f32 v204, v208, v209
  v_cvt_pk_bf16_f32 v205, v210, v211
  v_cvt_pk_bf16_f32 v206, v212, v213
  v_cvt_pk_bf16_f32 v207, v214, v215
  s_waitcnt lgkmcnt(7)
  v_mfma_f32_32x32x16_bf16 v[216:231], a[0:3], v[36:39], v[216:231]
L_pad6:
  s_cbranch_execz L_body
  buffer_load_dwordx4 v12, s[44:47], s76 offen offset:1024  lds
  ds_read_b64_tr_b16 a[20:21], v14 offset:20992
  ds_read_b64_tr_b16 a[22:23], v14 offset:23040
  v_pk_max_i16 v204, v204, 0
  v_pk_max_i16 v205, v205, 0
  v_pk_max_i16 v206, v206, 0
  v_pk_max_i16 v207, v207, 0
  v_mfma_f32_32x32x16_bf16 v[216:231], a[4:7], v[40:43], v[216:231]
  buffer_store_dwordx4 v[204:207], v253, s[32:35], s71 offen offset:2560 sc1
  ds_read_b64_tr_b16 a[24:25], v14 offset:22016
  ds_read_b64_tr_b16 a[26:27], v14 offset:24064
  s_waitcnt lgkmcnt(6)
  v_mfma_f32_32x32x16_bf16 v[216:231], a[8:11], v[44:47], v[216:231]
  s_add_u32 m0, s77, 4096
  s_add_u32 s76, s12, 73728
  buffer_load_dwordx4 v9, s[44:47], s76 offen  lds
  ds_read_b64_tr_b16 a[28:29], v14 offset:25088
  ds_read_b64_tr_b16 a[30:31], v14 offset:27136
  v_mfma_f32_32x32x16_bf16 v[216:231], a[12:15], v[48:51], v[216:231]
  buffer_load_dword v255, v251, s[52:55], s18 offen offset:256 sc1
  ds_read_b64_tr_b16 a[0:1], v14 offset:26112
  ds_read_b64_tr_b16 a[2:3], v14 offset:28160
  s_waitcnt lgkmcnt(6)
  v_mfma_f32_32x32x16_bf16 v[216:231], a[16:19], v[52:55], v[216:231]
  buffer_load_dwordx4 v12, s[44:47], s76 offen offset:1024  lds
  ds_read_b64_tr_b16 a[4:5], v14 offset:29184
  ds_read_b64_tr_b16 a[6:7], v14 offset:31232
  v_mfma_f32_32x32x16_bf16 v[216:231], a[20:23], v[56:59], v[216:231]
  ds_read_b64_tr_b16 a[8:9], v14 offset:30208
  ds_read_b64_tr_b16 a[10:11], v14 offset:32256
  ds_read_b64_tr_b16 a[148:149], v183 offset:8192
  s_waitcnt lgkmcnt(7)
  v_mfma_f32_32x32x16_bf16 v[216:231], a[24:27], v[60:63], v[216:231]
  s_add_u32 m0, s77, 0
  s_add_u32 s76, s12, 196608
  buffer_load_dwordx4 v9, s[44:47], s76 offen  lds
  ds_read_b64_tr_b16 a[12:13], v14 offset:33280
  ds_read_b64_tr_b16 a[14:15], v14 offset:35328
  v_mfma_f32_32x32x16_bf16 v[216:231], a[28:31], v[64:67], v[216:231]
  ds_read_b64_tr_b16 a[16:17], v14 offset:34304
  ds_read_b64_tr_b16 a[18:19], v14 offset:36352
  ds_read_b64_tr_b16 a[152:153], v182 offset:8704
  s_waitcnt lgkmcnt(8)
  v_mfma_f32_32x32x16_bf16 v[216:231], a[0:3], v[68:71], v[216:231]
  buffer_load_dwordx4 v12, s[44:47], s76 offen offset:1024  lds
  ds_read_b64_tr_b16 a[20:21], v14 offset:37376
  ds_read_b64_tr_b16 a[22:23], v14 offset:39424
  v_mfma_f32_32x32x16_bf16 v[216:231], a[4:7], v[72:75], v[216:231]
  ds_read_b64_tr_b16 a[24:25], v14 offset:38400
  ds_read_b64_tr_b16 a[26:27], v14 offset:40448
  ds_read_b64_tr_b16 a[156:157], v183 offset:8704
  s_waitcnt lgkmcnt(8)
  v_mfma_f32_32x32x16_bf16 v[216:231], a[8:11], v[76:79], v[216:231]
  s_add_u32 m0, s77, 2048
  s_add_u32 s76, s12, 204800
  buffer_load_dwordx4 v9, s[44:47], s76 offen  lds
  ds_read_b64_tr_b16 a[28:29], v14 offset:41472
  ds_read_b64_tr_b16 a[30:31], v14 offset:43520
  v_mfma_f32_32x32x16_bf16 v[216:231], a[12:15], v[80:83], v[216:231]
  ds_read_b64_tr_b16 a[0:1], v14 offset:42496
  ds_read_b64_tr_b16 a[2:3], v14 offset:44544
  ds_read_b64_tr_b16 a[146:147], v182 offset:16384
  s_waitcnt lgkmcnt(8)
  v_mfma_f32_32x32x16_bf16 v[216:231], a[16:19], v[84:87], v[216:231]
  buffer_load_dwordx4 v12, s[44:47], s76 offen offset:1024  lds
  ds_read_b64_tr_b16 a[4:5], v14 offset:45568
  ds_read_b64_tr_b16 a[6:7], v14 offset:47616
  ds_read_b32 v176, v176
  s_waitcnt vmcnt(5)
  v_cmp_ne_u32 vcc, s65, v255
  s_cbranch_vccnz L_pagain_35
L_pok_37:
  v_mfma_f32_32x32x16_bf16 v[216:231], a[20:23], v[88:91], v[216:231]
  s_add_u32 s4, s8, 0
  buffer_load_dwordx4 v[16:19], v2, s[52:55], s4 offen sc1
  ds_read_b64_tr_b16 a[8:9], v14 offset:46592
  ds_read_b64_tr_b16 a[10:11], v14 offset:48640
  s_waitcnt lgkmcnt(8)
  v_mfma_f32_32x32x16_bf16 v[216:231], a[24:27], v[92:95], v[216:231]
  buffer_load_dwordx4 v[20:23], v250, s[52:55], s4 offen sc1
  s_add_u32 s4, s8, 4096
  ds_read_b64_tr_b16 a[12:13], v14 offset:49664
  ds_read_b64_tr_b16 a[14:15], v14 offset:51712
  v_mfma_f32_32x32x16_bf16 v[216:231], a[28:31], v[96:99], v[216:231]
  buffer_load_dwordx4 v[24:27], v2, s[52:55], s4 offen sc1
  ds_read_b64_tr_b16 a[16:17], v14 offset:50688
  ds_read_b64_tr_b16 a[18:19], v14 offset:52736
  s_waitcnt lgkmcnt(7)
  v_mfma_f32_32x32x16_bf16 v[216:231], a[0:3], v[100:103], v[216:231]
  buffer_load_dwordx4 v[28:31], v250, s[52:55], s4 offen sc1
  s_add_u32 s4, s8, 8192
  ds_read_b64_tr_b16 a[20:21], v14 offset:53760
  ds_read_b64_tr_b16 a[22:23], v14 offset:55808
  v_mfma_f32_32x32x16_bf16 v[216:231], a[4:7], v[104:107], v[216:231]
  buffer_load_dwordx4 v[32:35], v2, s[52:55], s4 offen sc1
  ds_read_b64_tr_b16 a[24:25], v14 offset:54784
  ds_read_b64_tr_b16 a[26:27], v14 offset:56832
  s_waitcnt lgkmcnt(6)
  v_mfma_f32_32x32x16_bf16 v[216:231], a[8:11], v[108:111], v[216:231]
  buffer_load_dwordx4 v[36:39], v250, s[52:55], s4 offen sc1
  s_add_u32 s4, s8, 12288
  ds_read_b64_tr_b16 a[28:29], v14 offset:57856
  ds_read_b64_tr_b16 a[30:31], v14 offset:59904
  v_mfma_f32_32x32x16_bf16 v[216:231], a[12:15], v[112:115], v[216:231]
  buffer_load_dwordx4 v[40:43], v2, s[52:55], s4 offen sc1
  s_add_u32 s4, s7, 0
  ds_read_b64_tr_b16 a[0:1], v14 offset:58880
  ds_read_b64_tr_b16 a[2:3], v14 offset:60928
  s_waitcnt lgkmcnt(6)
  v_mfma_f32_32x32x16_bf16 v[216:231], a[16:19], v[116:119], v[216:231]
  buffer_load_dwordx4 v[44:47], v2, s[52:55], s4 offen sc1
  ds_read_b64_tr_b16 a[4:5], v14 offset:61952
  ds_read_b64_tr_b16 a[6:7], v14 offset:64000
  v_mfma_f32_32x32x16_bf16 v[216:231], a[20:23], v[120:123], v[216:231]
  ds_read_b64_tr_b16 a[8:9], v14 offset:62976
  ds_read_b64_tr_b16 a[10:11], v14 offset:65024
  ds_read_b64_tr_b16 a[150:151], v183 offset:16384
  s_waitcnt lgkmcnt(7)
  v_mfma_f32_32x32x16_bf16 v[216:231], a[24:27], v[124:127], v[216:231]
  ds_read_b128 a[12:15], v248 offset:1536
  ds_read_b64_tr_b16 a[154:155], v182 offset:16896
  ds_read_b64_tr_b16 a[158:159], v183 offset:16896
  s_waitcnt lgkmcnt(0)
  v_mfma_f32_32x32x16_bf16 v[216:231], a[28:31], v[128:131], v[216:231]
  v_mfma_f32_32x32x16_bf16 v[216:231], a[0:3], v[132:135], v[216:231]
  v_mfma_f32_32x32x16_bf16 v[216:231], a[4:7], v[136:139], v[216:231]
  v_mfma_f32_32x32x16_bf16 v[216:231], a[8:11], v[140:143], v[216:231]
  v_mfma_f32_32x32x16_bf16 v[216:231], a[12:15], v[232:235], v[216:231]
  v_mov_b32 v3, s65
  s_mov_b64 exec, 1
  s_cmp_eq_u32 s67, 0
  s_cbranch_scc1 L_slow_38
  buffer_store_dword v3, off, s[52:55], s72 offset:128
L_back_39:
  s_mov_b64 exec, -1
  s_waitcnt vmcnt(8)
  v_mfma_f32_16x16x32_bf16 v[128:131], a[32:35], v[16:19], 0
  s_nop 3
  v_cvt_pk_bf16_f32 v216, v216, v217
  v_cvt_pk_bf16_f32 v217, v218, v219
  v_mfma_f32_16x16x32_bf16 v[132:135], a[36:39], v[16:19], 0
  v_cvt_pk_bf16_f32 v218, v220, v221
  v_cvt_pk_bf16_f32 v219, v222, v223
  v_mfma_f32_16x16x32_bf16 v[136:139], a[40:43], v[16:19], 0
  v_pk_max_i16 v216, v216, 0
  v_pk_max_i16 v217, v217, 0
  v_mfma_f32_16x16x32_bf16 v[140:143], a[44:47], v[16:19], 0
  v_pk_max_i16 v218, v218, 0
  s_waitcnt vmcnt(7)
  v_mfma_f32_16x16x32_bf16 v[128:131], a[48:51], v[20:23], v[128:131]
  v_pk_max_i16 v219, v219, 0
  v_mfma_f32_16x16x32_bf16 v[132:135], a[52:55], v[20:23], v[132:135]
  buffer_store_dwordx4 v[216:219], v253, s[32:35], s71 offen offset:3072 sc1
  v_mfma_f32_16x16x32_bf16 v[136:139], a[56:59], v[20:23], v[136:139]
  v_cvt_pk_bf16_f32 v220, v224, v225
  v_cvt_pk_bf16_f32 v221, v226, v227
  v_mfma_f32_16x16x32_bf16 v[140:143], a[60:63], v[20:23], v[140:143]
  v_cvt_pk_bf16_f32 v222, v228, v229
  s_waitcnt vmcnt(7)
  v_mfma_f32_16x16x32_bf16 v[128:131], a[64:67], v[24:27], v[128:131]
  v_cvt_pk_bf16_f32 v223, v230, v231
  v_pk_max_i16 v220, v220, 0
  v_mfma_f32_16x16x32_bf16 v[132:135], a[68:71], v[24:27], v[132:135]
  v_pk_max_i16 v221, v221, 0
  v_pk_max_i16 v222, v222, 0
  v_mfma_f32_16x16x32_bf16 v[136:139], a[72:75], v[24:27], v[136:139]
  v_pk_max_i16 v223, v223, 0
  v_mfma_f32_16x16x32_bf16 v[140:143], a[76:79], v[24:27], v[140:143]
  buffer_store_dwordx4 v[220:223], v253, s[32:35], s71 offen offset:3584 sc1
  s_waitcnt vmcnt(7)
  v_mfma_f32_16x16x32_bf16 v[128:131], a[80:83], v[28:31], v[128:131]
  buffer_load_dwordx4 v[48:51], v250, s[52:55], s4 offen sc1
  s_add_u32 s4, s7, 4096
  v_mfma_f32_16x16x32_bf16 v[132:135], a[84:87], v[28:31], v[132:135]
  ds_read_b64_tr_b16 a[160:161], v182 offset:24576
  v_lshlrev_b32 v160, 16, v240
  v_mfma_f32_16x16x32_bf16 v[136:139], a[88:91], v[28:31], v[136:139]
  buffer_load_dwordx4 v[52:55], v2, s[52:55], s4 offen sc1
  v_mfma_f32_16x16x32_bf16 v[140:143], a[92:95], v[28:31], v[140:143]
  ds_read_b64_tr_b16 a[164:165], v183 offset:24576
  s_waitcnt vmcnt(8)
  v_mfma_f32_16x16x32_bf16 v[128:131], a[96:99], v[32:35], v[128:131]
  buffer_load_dwordx4 v[56:59], v250, s[52:55], s4 offen sc1
  s_add_u32 s4, s7, 8192
  v_mfma_f32_16x16x32_bf16 v[132:135], a[100:103], v[32:35], v[132:135]
  ds_read_b64_tr_b16 a[168:169], v182 offset:25088
  v_and_b32 v161, s68, v240
  v_mfma_f32_16x16x32_bf16 v[136:139], a[104:107], v[32:35], v[136:139]
  buffer_load_dwordx4 v[60:63], v2, s[52:55], s4 offen sc1
  v_mfma_f32_16x16x32_bf16 v[140:143], a[108:111], v[32:35], v[140:143]
  ds_read_b64_tr_b16 a[172:173], v183 offset:25088
  s_waitcnt vmcnt(9)
  v_mfma_f32_16x16x32_bf16 v[128:131], a[112:115], v[36:39], v[128:131]
  buffer_load_dwordx4 v[64:67], v250, s[52:55], s4 offen sc1
  s_add_u32 s4, s7, 12288
  v_mfma_f32_16x16x32_bf16 v[132:135], a[116:119], v[36:39], v[132:135]
  ds_read_b64_tr_b16 a[162:163], v182 offset:32768
  v_lshlrev_b32 v162, 16, v241
  v_mfma_f32_16x16x32_bf16 v[136:139], a[120:123], v[36:39], v[136:139]
  buffer_load_dwordx4 v[68:71], v2, s[52:55], s4 offen sc1
  s_add_u32 s4, s6, 0
  v_mfma_f32_16x16x32_bf16 v[140:143], a[124:127], v[36:39], v[140:143]
  ds_read_b64_tr_b16 a[166:167], v183 offset:32768
  s_waitcnt vmcnt(10)
  v_mfma_f32_16x16x32_bf16 v[128:131], a[128:131], v[40:43], v[128:131]
  buffer_load_dwordx4 v[72:75], v2, s[52:55], s4 offen sc1
  v_mfma_f32_16x16x32_bf16 v[132:135], a[132:135], v[40:43], v[132:135]
  ds_read_b64_tr_b16 a[170:171], v182 offset:33280
  v_and_b32 v163, s68, v241
  v_mfma_f32_16x16x32_bf16 v[136:139], a[136:139], v[40:43], v[136:139]
  buffer_load_dword v255, v251, s[52:55], s18 offen offset:384 sc1
  v_mfma_f32_16x16x32_bf16 v[140:143], a[140:143], v[40:43], v[140:143]
  ds_read_b64_tr_b16 a[174:175], v183 offset:33280
  s_waitcnt vmcnt(11)
  v_mfma_f32_16x16x32_bf16 v[112:115], a[32:35], v[44:47], 0
  buffer_load_dwordx4 v[76:79], v250, s[52:55], s4 offen sc1
  s_add_u32 s4, s6, 4096
  v_mfma_f32_16x16x32_bf16 v[116:119], a[36:39], v[44:47], 0
  s_waitcnt lgkmcnt(0)
  ds_read_b64_tr_b16 a[176:177], v182 offset:40960
  v_mfma_f32_16x16x32_bf16 v[120:123], a[40:43], v[44:47], 0
  s_add_u32 m0, s13, 0
  s_add_u32 s76, s12, 327680
  buffer_load_dwordx4 v9, s[44:47], s76 offen  lds
  v_mfma_f32_16x16x32_bf16 v[124:127], a[44:47], v[44:47], 0
  ds_read_b64_tr_b16 a[180:181], v183 offset:40960
  s_waitcnt vmcnt(9)
  v_mov_b32 v3, s65
  s_mov_b64 exec, 1
  s_cmp_eq_u32 s67, 0
  s_cbranch_scc1 L_slow_40
  buffer_store_dword v3, off, s[52:55], s72 offset:256
L_back_41:
  s_mov_b64 exec, -1
  v_mfma_f32_16x16x32_bf16 v[112:115], a[48:51], v[48:51], v[112:115]
  buffer_load_dwordx4 v[16:19], v2, s[52:55], s4 offen sc1
  v_mfma_f32_16x16x32_bf16 v[116:119], a[52:55], v[48:51], v[116:119]
  ds_read_b64_tr_b16 a[184:185], v182 offset:41472
  v_lshlrev_b32 v164, 16, v242
  v_mfma_f32_16x16x32_bf16 v[120:123], a[56:59], v[48:51], v[120:123]
  buffer_load_dwordx4 v12, s[44:47], s76 offen offset:1024  lds
  v_mfma_f32_16x16x32_bf16 v[124:127], a[60:63], v[48:51], v[124:127]
  ds_read_b64_tr_b16 a[188:189], v183 offset:41472
  s_waitcnt vmcnt(11)
  v_mfma_f32_16x16x32_bf16 v[112:115], a[64:67], v[52:55], v[112:115]
  buffer_load_dwordx4 v[20:23], v250, s[52:55], s4 offen sc1
  s_add_u32 s4, s6, 8192
  v_mfma_f32_16x16x32_bf16 v[116:119], a[68:71], v[52:55], v[116:119]
  ds_read_b64_tr_b16 a[178:179], v182 offset:49152
  v_and_b32 v165, s68, v242
  v_mfma_f32_16x16x32_bf16 v[120:123], a[72:75], v[52:55], v[120:123]
  s_add_u32 m0, s13, 8192
  s_add_u32 s76, s12, 335872
  buffer_load_dwordx4 v9, s[44:47], s76 offen  lds
  v_mfma_f32_16x16x32_bf16 v[124:127], a[76:79], v[52:55], v[124:127]
  ds_read_b64_tr_b16 a[182:183], v183 offset:49152
  s_waitcnt vmcnt(12)
  v_mfma_f32_16x16x32_bf16 v[112:115], a[80:83], v[56:59], v[112:115]
  buffer_load_dwordx4 v[24:27], v2, s[52:55], s4 offen sc1
  v_mfma_f32_16x16x32_bf16 v[116:119], a[84:87], v[56:59], v[116:119]
  ds_read_b64_tr_b16 a[186:187], v182 offset:49664
  v_lshlrev_b32 v166, 16, v243
  v_mfma_f32_16x16x32_bf16 v[120:123], a[88:91], v[56:59], v[120:123]
  buffer_load_dwordx4 v12, s[44:47], s76 offen offset:1024  lds
  v_mfma_f32_16x16x32_bf16 v[124:127], a[92:95], v[56:59], v[124:127]
  ds_read_b64_tr_b16 a[190:191], v183 offset:49664
  s_waitcnt vmcnt(13)
  v_mfma_f32_16x16x32_bf16 v[112:115], a[96:99], v[60:63], v[112:115]
  buffer_load_dwordx4 v[28:31], v250, s[52:55], s4 offen sc1
  s_add_u32 s4, s6, 12288
  v_mfma_f32_16x16x32_bf16 v[116:119], a[100:103], v[60:63], v[116:119]
  s_waitcnt lgkmcnt(0)
  ds_read_b64_tr_b16 a[192:193], v182 offset:57344
  v_mfma_f32_16x16x32_bf16 v[120:123], a[104:107], v[60:63], v[120:123]
  s_add_u32 m0, s13, 16384
  s_add_u32 s76, s75, 458752
  buffer_load_dwordx4 v9, s[44:47], s76 offen  lds
  v_mfma_f32_16x16x32_bf16 v[124:127], a[108:111], v[60:63], v[124:127]
  ds_read_b64_tr_b16 a[196:197], v183 offset:57344
  s_waitcnt vmcnt(14)
  v_mfma_f32_16x16x32_bf16 v[112:115], a[112:115], v[64:67], v[112:115]
  buffer_load_dwordx4 v[32:35], v2, s[52:55], s4 offen sc1
  s_add_u32 s4, s5, 0
  v_mfma_f32_16x16x32_bf16 v[116:119], a[116:119], v[64:67], v[116:119]
  ds_read_b64_tr_b16 a[200:201], v182 offset:57856
  v_and_b32 v167, s68, v243
  v_mfma_f32_16x16x32_bf16 v[120:123], a[120:123], v[64:67], v[120:123]
  buffer_load_dwordx4 v12, s[44:47], s76 offen offset:1024  lds
  v_mfma_f32_16x16x32_bf16 v[124:127], a[124:127], v[64:67], v[124:127]
  ds_read_b64_tr_b16 a[204:205], v183 offset:57856
  s_waitcnt vmcnt(15)
  v_mfma_f32_16x16x32_bf16 v[112:115], a[128:131], v[68:71], v[112:115]
  buffer_load_dwordx4 v[36:39], v2, s[52:55], s4 offen sc1
  v_mfma_f32_16x16x32_bf16 v[116:119], a[132:135], v[68:71], v[116:119]
  ds_read_b64_tr_b16 a[194:195], v180 offset:4096
  v_lshlrev_b32 v168, 16, v244
  v_mfma_f32_16x16x32_bf16 v[120:123], a[136:139], v[68:71], v[120:123]
  s_add_u32 m0, s13, 24576
  s_add_u32 s76, s75, 466944
  buffer_load_dwordx4 v9, s[44:47], s76 offen  lds
  v_mfma_f32_16x16x32_bf16 v[124:127], a[140:143], v[68:71], v[124:127]
  ds_read_b64_tr_b16 a[198:199], v181 offset:4096
  s_waitcnt vmcnt(16)
  v_mfma_f32_16x16x32_bf16 v[96:99], a[32:35], v[72:75], 0
  buffer_load_dwordx4 v[40:43], v250, s[52:55], s4 offen sc1
  s_add_u32 s4, s5, 4096
  v_mfma_f32_16x16x32_bf16 v[100:103], a[36:39], v[72:75], 0
  ds_read_b64_tr_b16 a[202:203], v180 offset:4608
  v_and_b32 v169, s68, v244
  v_mfma_f32_16x16x32_bf16 v[104:107], a[40:43], v[72:75], 0
  buffer_load_dwordx4 v12, s[44:47], s76 offen offset:1024  lds
  v_mfma_f32_16x16x32_bf16 v[108:111], a[44:47], v[72:75], 0
  ds_read_b64_tr_b16 a[206:207], v181 offset:4608
  s_waitcnt vmcnt(16)
  v_cmp_ne_u32 vcc, s65, v255
  s_cbranch_vccnz L_pagain_42
L_pok_44:
  v_mfma_f32_16x16x32_bf16 v[96:99], a[48:51], v[76:79], v[96:99]
  buffer_load_dwordx4 v[44:47], v2, s[52:55], s4 offen sc1
  v_mfma_f32_16x16x32_bf16 v[100:103], a[52:55], v[76:79], v[100:103]
  s_waitcnt lgkmcnt(0)
  ds_read_b64_tr_b16 a[208:209], v180 offset:0
  v_mfma_f32_16x16x32_bf16 v[104:107], a[56:59], v[76:79], v[104:107]
  ds_read_b64_tr_b16 a[212:213], v181 offset:0
  v_lshlrev_b32 v170, 16, v245
  v_mfma_f32_16x16x32_bf16 v[108:111], a[60:63], v[76:79], v[108:111]
  ds_read_b64_tr_b16 a[216:217], v180 offset:512
  s_waitcnt vmcnt(14)
  v_mfma_f32_16x16x32_bf16 v[96:99], a[64:67], v[16:19], v[96:99]
  buffer_load_dwordx4 v[48:51], v250, s[52:55], s4 offen sc1
  s_add_u32 s4, s8, 2048
  v_mfma_f32_16x16x32_bf16 v[100:103], a[68:71], v[16:19], v[100:103]
  ds_read_b64_tr_b16 a[220:221], v181 offset:512
  v_and_b32 v171, s68, v245
  v_mfma_f32_16x16x32_bf16 v[104:107], a[72:75], v[16:19], v[104:107]
  ds_read_b64_tr_b16 a[210:211], v180 offset:2048
  v_lshlrev_b32 v172, 16, v246
  v_mfma_f32_16x16x32_bf16 v[108:111], a[76:79], v[16:19], v[108:111]
  ds_read_b64_tr_b16 a[214:215], v181 offset:2048
  s_waitcnt vmcnt(13)
  v_mfma_f32_16x16x32_bf16 v[96:99], a[80:83], v[20:23], v[96:99]
  buffer_load_dwordx4 v[52:55], v236, s[52:55], s4 offen sc1
  s_add_u32 s4, s8, 6144
  v_mfma_f32_16x16x32_bf16 v[100:103], a[84:87], v[20:23], v[100:103]
  ds_read_b64_tr_b16 a[218:219], v180 offset:2560
  v_and_b32 v173, s68, v246
  v_mfma_f32_16x16x32_bf16 v[104:107], a[88:91], v[20:23], v[104:107]
  buffer_load_dword v255, v251, s[52:55], s18 offen offset:512 sc1
  v_mfma_f32_16x16x32_bf16 v[108:111], a[92:95], v[20:23], v[108:111]
  ds_read_b64_tr_b16 a[222:223], v181 offset:2560
  s_waitcnt vmcnt(13)
  v_mfma_f32_16x16x32_bf16 v[96:99], a[96:99], v[24:27], v[96:99]
  buffer_load_dwordx4 v[56:59], v236, s[52:55], s4 offen sc1
  s_add_u32 s4, s8, 10240
  v_mfma_f32_16x16x32_bf16 v[100:103], a[100:103], v[24:27], v[100:103]
  s_waitcnt lgkmcnt(0)
  ds_read_b64_tr_b16 a[224:225], v182 offset:0
  v_mfma_f32_16x16x32_bf16 v[104:107], a[104:107], v[24:27], v[104:107]
  ds_read_b64_tr_b16 a[228:229], v183 offset:0
  v_lshlrev_b32 v174, 16, v247
  v_mfma_f32_16x16x32_bf16 v[108:111], a[108:111], v[24:27], v[108:111]
  ds_read_b64_tr_b16 a[232:233], v182 offset:512
  s_waitcnt vmcnt(12)
  v_mfma_f32_16x16x32_bf16 v[96:99], a[112:115], v[28:31], v[96:99]
  buffer_load_dwordx4 v[60:63], v236, s[52:55], s4 offen sc1
  s_add_u32 s4, s7, 2048
  v_mfma_f32_16x16x32_bf16 v[100:103], a[116:119], v[28:31], v[100:103]
  ds_read_b64_tr_b16 a[236:237], v183 offset:512
  s_waitcnt lgkmcnt(0)
  v_mfma_f32_16x16x32_bf16 v[104:107], a[120:123], v[28:31], v[104:107]
  ds_read_b64_tr_b16 a[226:227], v182 offset:8192
  v_and_b32 v175, s68, v247
  v_mfma_f32_16x16x32_bf16 v[108:111], a[124:127], v[28:31], v[108:111]
  ds_read_b64_tr_b16 a[230:231], v183 offset:8192
  s_waitcnt vmcnt(11)
  v_mfma_f32_16x16x32_bf16 v[96:99], a[128:131], v[32:35], v[96:99]
  buffer_load_dwordx4 v[64:67], v236, s[52:55], s4 offen sc1
  s_add_u32 s4, s7, 6144
  v_mfma_f32_16x16x32_bf16 v[100:103], a[132:135], v[32:35], v[100:103]
  ds_read_b64_tr_b16 a[234:235], v182 offset:8704
  v_lshlrev_b32 v15, 4, v1
  v_mfma_f32_16x16x32_bf16 v[104:107], a[136:139], v[32:35], v[104:107]
  ds_read_b64_tr_b16 a[238:239], v183 offset:8704
  s_waitcnt lgkmcnt(0)
  v_mfma_f32_16x16x32_bf16 v[108:111], a[140:143], v[32:35], v[108:111]
  s_xor_b32 s3, s60, 1
  s_waitcnt vmcnt(10)
  v_mfma_f32_16x16x32_bf16 v[80:83], a[32:35], v[36:39], 0
  buffer_load_dwordx4 v[68:71], v236, s[52:55], s4 offen sc1
  s_add_u32 s4, s7, 10240
  v_mfma_f32_16x16x32_bf16 v[84:87], a[36:39], v[36:39], 0
  ds_read_b64_tr_b16 a[240:241], v182 offset:16384
  s_mul_i32 s3, s3, 12288
  v_mfma_f32_16x16x32_bf16 v[88:91], a[40:43], v[36:39], 0
  ds_read_b64_tr_b16 a[244:245], v183 offset:16384
  s_add_u32 s3, s3, 65536
  v_mfma_f32_16x16x32_bf16 v[92:95], a[44:47], v[36:39], 0
  ds_read_b64_tr_b16 a[248:249], v182 offset:16896
  s_waitcnt vmcnt(9)
  v_mfma_f32_16x16x32_bf16 v[80:83], a[48:51], v[40:43], v[80:83]
  buffer_load_dwordx4 v[72:75], v236, s[52:55], s4 offen sc1
  s_add_u32 s4, s6, 2048
  v_mfma_f32_16x16x32_bf16 v[84:87], a[52:55], v[40:43], v[84:87]
  ds_read_b64_tr_b16 a[252:253], v183 offset:16896
  s_waitcnt lgkmcnt(0)
  v_mfma_f32_16x16x32_bf16 v[88:91], a[56:59], v[40:43], v[88:91]
  v_add_u32 v5, s3, v15
  s_xor_b32 s3, s60, 2
  v_mfma_f32_16x16x32_bf16 v[92:95], a[60:63], v[40:43], v[92:95]
  s_mul_i32 s3, s3, 12288
  s_waitcnt vmcnt(8)
  v_mfma_f32_16x16x32_bf16 v[80:83], a[64:67], v[44:47], v[80:83]
  buffer_load_dwordx4 v[76:79], v236, s[52:55], s4 offen sc1
  s_add_u32 s4, s6, 6144
  v_mfma_f32_16x16x32_bf16 v[84:87], a[68:71], v[44:47], v[84:87]
  ds_read_b64_tr_b16 a[242:243], v182 offset:24576
  s_add_u32 s3, s3, 69632
  v_mfma_f32_16x16x32_bf16 v[88:91], a[72:75], v[44:47], v[88:91]
  ds_read_b64_tr_b16 a[246:247], v183 offset:24576
  v_add_u32 v6, s3, v15
  v_mfma_f32_16x16x32_bf16 v[92:95], a[76:79], v[44:47], v[92:95]
  ds_read_b64_tr_b16 a[250:251], v182 offset:25088
  s_waitcnt vmcnt(8)
  v_mfma_f32_16x16x32_bf16 v[80:83], a[80:83], v[48:51], v[80:83]
  buffer_load_dwordx4 v[16:19], v236, s[52:55], s4 offen sc1
  s_add_u32 s4, s6, 10240
  v_mfma_f32_16x16x32_bf16 v[84:87], a[84:87], v[48:51], v[84:87]
  ds_read_b64_tr_b16 a[254:255], v183 offset:25088
  s_waitcnt lgkmcnt(0)
  v_mfma_f32_16x16x32_bf16 v[88:91], a[88:91], v[48:51], v[88:91]
  s_xor_b32 s3, s60, 3
  s_mul_i32 s3, s3, 12288
  v_mfma_f32_16x16x32_bf16 v[92:95], a[92:95], v[48:51], v[92:95]
  s_add_u32 s3, s3, 73728
  s_waitcnt vmcnt(8)
  v_mfma_f32_16x16x32_bf16 v[128:131], a[144:147], v[52:55], v[128:131]
  buffer_load_dwordx4 v[20:23], v236, s[52:55], s4 offen sc1
  s_add_u32 s4, s8, 2048
  v_mfma_f32_16x16x32_bf16 v[132:135], a[148:151], v[52:55], v[132:135]
  v_add_u32 v7, s3, v15
  s_mul_i32 s3, s60, 12288
  v_mfma_f32_16x16x32_bf16 v[136:139], a[152:155], v[52:55], v[136:139]
  s_add_u32 s3, s3, 65536
  v_add_u32 v8, s3, v15
  v_mfma_f32_16x16x32_bf16 v[140:143], a[156:159], v[52:55], v[140:143]
  v_mul_f32 v160, v160, v176
  s_waitcnt vmcnt(7)
  v_cmp_ne_u32 vcc, s65, v255
  s_cbranch_vccnz L_pagain_45
L_pok_47:
  v_mfma_f32_16x16x32_bf16 v[128:131], a[160:163], v[56:59], v[128:131]
  buffer_load_dwordx4 v[24:27], v237, s[52:55], s4 offen sc1
  s_add_u32 s4, s8, 6144
  v_mfma_f32_16x16x32_bf16 v[132:135], a[164:167], v[56:59], v[132:135]
  v_mul_f32 v161, v161, v176
  v_mul_f32 v162, v162, v176
  v_mfma_f32_16x16x32_bf16 v[136:139], a[168:171], v[56:59], v[136:139]
  v_mul_f32 v163, v163, v176
  v_mul_f32 v164, v164, v176
  v_mfma_f32_16x16x32_bf16 v[140:143], a[172:175], v[56:59], v[140:143]
  v_mul_f32 v165, v165, v176
  s_waitcnt vmcnt(7)
  v_mfma_f32_16x16x32_bf16 v[128:131], a[176:179], v[60:63], v[128:131]
  buffer_load_dwordx4 v[28:31], v237, s[52:55], s4 offen sc1
  s_add_u32 s4, s8, 10240
  v_mfma_f32_16x16x32_bf16 v[132:135], a[180:183], v[60:63], v[132:135]
  v_mul_f32 v166, v166, v176
  v_mul_f32 v167, v167, v176
  v_mfma_f32_16x16x32_bf16 v[136:139], a[184:187], v[60:63], v[136:139]
  v_mul_f32 v168, v168, v176
  v_mul_f32 v169, v169, v176
  v_mfma_f32_16x16x32_bf16 v[140:143], a[188:191], v[60:63], v[140:143]
  v_mul_f32 v170, v170, v176
  s_waitcnt vmcnt(7)
  v_mfma_f32_16x16x32_bf16 v[112:115], a[144:147], v[64:67], v[112:115]
  buffer_load_dwordx4 v[32:35], v237, s[52:55], s4 offen sc1
  s_add_u32 s4, s8, 14336
  v_mfma_f32_16x16x32_bf16 v[116:119], a[148:151], v[64:67], v[116:119]
  v_mul_f32 v171, v171, v176
  v_mul_f32 v172, v172, v176
  v_mfma_f32_16x16x32_bf16 v[120:123], a[152:155], v[64:67], v[120:123]
  v_mul_f32 v173, v173, v176
  v_mul_f32 v174, v174, v176
  v_mfma_f32_16x16x32_bf16 v[124:127], a[156:159], v[64:67], v[124:127]
  v_mul_f32 v175, v175, v176
  s_waitcnt vmcnt(7)
  v_mfma_f32_16x16x32_bf16 v[112:115], a[160:163], v[68:71], v[112:115]
  buffer_load_dwordx4 v[36:39], v2, s[52:55], s4 offen sc1
  s_add_u32 s4, s7, 2048
  v_mfma_f32_16x16x32_bf16 v[116:119], a[164:167], v[68:71], v[116:119]
  v_mfma_f32_16x16x32_bf16 v[120:123], a[168:171], v[68:71], v[120:123]
  v_mfma_f32_16x16x32_bf16 v[124:127], a[172:175], v[68:71], v[124:127]
  s_waitcnt vmcnt(7)
  v_mfma_f32_16x16x32_bf16 v[112:115], a[176:179], v[72:75], v[112:115]
  buffer_load_dwordx4 v[40:43], v237, s[52:55], s4 offen sc1
  s_add_u32 s4, s7, 6144
  v_mfma_f32_16x16x32_bf16 v[116:119], a[180:183], v[72:75], v[116:119]
  v_mfma_f32_16x16x32_bf16 v[120:123], a[184:187], v[72:75], v[120:123]
  v_mfma_f32_16x16x32_bf16 v[124:127], a[188:191], v[72:75], v[124:127]
  s_waitcnt vmcnt(7)
  v_mfma_f32_16x16x32_bf16 v[96:99], a[144:147], v[76:79], v[96:99]
  buffer_load_dwordx4 v[44:47], v237, s[52:55], s4 offen sc1
  s_add_u32 s4, s7, 10240
  v_mfma_f32_16x16x32_bf16 v[100:103], a[148:151], v[76:79], v[100:103]
  v_mfma_f32_16x16x32_bf16 v[104:107], a[152:155], v[76:79], v[104:107]
  v_mfma_f32_16x16x32_bf16 v[108:111], a[156:159], v[76:79], v[108:111]
  s_waitcnt vmcnt(7)
  v_mfma_f32_16x16x32_bf16 v[96:99], a[160:163], v[16:19], v[96:99]
  buffer_load_dwordx4 v[48:51], v237, s[52:55], s4 offen sc1
  s_add_u32 s4, s7, 14336
  v_mfma_f32_16x16x32_bf16 v[100:103], a[164:167], v[16:19], v[100:103]
  v_mfma_f32_16x16x32_bf16 v[104:107], a[168:171], v[16:19], v[104:107]
  v_mfma_f32_16x16x32_bf16 v[108:111], a[172:175], v[16:19], v[108:111]
  s_waitcnt vmcnt(7)
  v_mfma_f32_16x16x32_bf16 v[96:99], a[176:179], v[20:23], v[96:99]
  buffer_load_dwordx4 v[52:55], v2, s[52:55], s4 offen sc1
  s_add_u32 s4, s6, 2048
  v_mfma_f32_16x16x32_bf16 v[100:103], a[180:183], v[20:23], v[100:103]
  v_mfma_f32_16x16x32_bf16 v[104:107], a[184:187], v[20:23], v[104:107]
  v_mfma_f32_16x16x32_bf16 v[108:111], a[188:191], v[20:23], v[108:111]
  s_waitcnt vmcnt(7)
  v_mfma_f32_16x16x32_bf16 v[128:131], a[192:195], v[24:27], v[128:131]
  buffer_load_dwordx4 v[56:59], v237, s[52:55], s4 offen sc1
  s_add_u32 s4, s6, 6144
  v_mfma_f32_16x16x32_bf16 v[132:135], a[196:199], v[24:27], v[132:135]
  v_mfma_f32_16x16x32_bf16 v[136:139], a[200:203], v[24:27], v[136:139]
  v_mfma_f32_16x16x32_bf16 v[140:143], a[204:207], v[24:27], v[140:143]
  s_waitcnt vmcnt(7)
  v_mfma_f32_16x16x32_bf16 v[128:131], a[208:211], v[28:31], v[128:131]
  buffer_load_dwordx4 v[60:63], v237, s[52:55], s4 offen sc1
  s_add_u32 s4, s6, 10240
  v_mfma_f32_16x16x32_bf16 v[132:135], a[212:215], v[28:31], v[132:135]
  v_mfma_f32_16x16x32_bf16 v[136:139], a[216:219], v[28:31], v[136:139]
  v_mfma_f32_16x16x32_bf16 v[140:143], a[220:223], v[28:31], v[140:143]
  s_waitcnt vmcnt(7)
  v_mfma_f32_16x16x32_bf16 v[128:131], a[224:227], v[32:35], v[128:131]
  buffer_load_dwordx4 v[64:67], v237, s[52:55], s4 offen sc1
  s_add_u32 s4, s6, 14336
  v_mfma_f32_16x16x32_bf16 v[132:135], a[228:231], v[32:35], v[132:135]
  v_mfma_f32_16x16x32_bf16 v[136:139], a[232:235], v[32:35], v[136:139]
  v_mfma_f32_16x16x32_bf16 v[140:143], a[236:239], v[32:35], v[140:143]
  s_waitcnt vmcnt(7)
  v_mfma_f32_16x16x32_bf16 v[128:131], a[240:243], v[36:39], v[128:131]
  buffer_load_dwordx4 v[68:71], v2, s[52:55], s4 offen sc1
  s_add_u32 s4, s5, 8192
  v_mfma_f32_16x16x32_bf16 v[132:135], a[244:247], v[36:39], v[132:135]
  v_mfma_f32_16x16x32_bf16 v[136:139], a[248:251], v[36:39], v[136:139]
  v_mfma_f32_16x16x32_bf16 v[140:143], a[252:255], v[36:39], v[140:143]
  s_waitcnt vmcnt(7)
  s_waitcnt lgkmcnt(0)
  s_barrier
  v_mfma_f32_16x16x32_bf16 v[112:115], a[192:195], v[40:43], v[112:115]
  buffer_load_dwordx4 v[72:75], v2, s[52:55], s4 offen sc1
  v_mfma_f32_16x16x32_bf16 v[116:119], a[196:199], v[40:43], v[116:119]
  v_and_b32 v4, 15, v1
  v_mul_u32_u24 v4, 144, v4
  v_mfma_f32_16x16x32_bf16 v[120:123], a[200:203], v[40:43], v[120:123]
  v_lshrrev_b32 v180, 4, v1
  v_lshl_add_u32 v4, v180, 3, v4
  v_mfma_f32_16x16x32_bf16 v[124:127], a[204:207], v[40:43], v[124:127]
  ds_write_b128 v7, v[128:131] offset:0
  s_waitcnt vmcnt(7)
  v_mfma_f32_16x16x32_bf16 v[112:115], a[208:211], v[44:47], v[112:115]
  buffer_load_dwordx4 v[76:79], v250, s[52:55], s4 offen sc1
  s_add_u32 s4, s5, 12288
  v_mfma_f32_16x16x32_bf16 v[116:119], a[212:215], v[44:47], v[116:119]
  v_add_u32 v180, s77, v4
  v_lshrrev_b32 v4, 3, v1
  v_mfma_f32_16x16x32_bf16 v[120:123], a[216:219], v[44:47], v[120:123]
  v_and_b32 v177, 0x70, v2
  v_mul_u32_u24 v181, 144, v4
  v_mfma_f32_16x16x32_bf16 v[124:127], a[220:223], v[44:47], v[124:127]
  ds_write_b128 v7, v[132:135] offset:1024
  s_waitcnt vmcnt(7)
  v_mfma_f32_16x16x32_bf16 v[112:115], a[224:227], v[48:51], v[112:115]
  buffer_load_dwordx4 v[16:19], v2, s[52:55], s4 offen sc1
  s_add_u32 s4, s5, 2048
  v_mfma_f32_16x16x32_bf16 v[116:119], a[228:231], v[48:51], v[116:119]
  v_add3_u32 v181, v181, v177, s77
  v_lshl_add_u32 v177, v4, 10, v177
  v_mfma_f32_16x16x32_bf16 v[120:123], a[232:235], v[48:51], v[120:123]
  s_add_u32 s3, s21, 8192
  v_mfma_f32_16x16x32_bf16 v[124:127], a[236:239], v[48:51], v[124:127]
  ds_write_b128 v7, v[136:139] offset:2048
  s_waitcnt vmcnt(7)
  v_mfma_f32_16x16x32_bf16 v[112:115], a[240:243], v[52:55], v[112:115]
  buffer_load_dwordx4 v[20:23], v236, s[52:55], s4 offen sc1
  s_add_u32 s4, s5, 6144
  v_mfma_f32_16x16x32_bf16 v[116:119], a[244:247], v[52:55], v[116:119]
L_pad7:
  s_cbranch_execz L_body
  v_mfma_f32_16x16x32_bf16 v[120:123], a[248:251], v[52:55], v[120:123]
  v_mfma_f32_16x16x32_bf16 v[124:127], a[252:255], v[52:55], v[124:127]
  ds_write_b128 v7, v[140:143] offset:3072
  s_waitcnt vmcnt(7)
  v_mfma_f32_16x16x32_bf16 v[96:99], a[192:195], v[56:59], v[96:99]
  buffer_load_dwordx4 v[24:27], v236, s[52:55], s4 offen sc1
  s_add_u32 s4, s5, 10240
  v_mfma_f32_16x16x32_bf16 v[100:103], a[196:199], v[56:59], v[100:103]
  v_mfma_f32_16x16x32_bf16 v[104:107], a[200:203], v[56:59], v[104:107]
  v_mfma_f32_16x16x32_bf16 v[108:111], a[204:207], v[56:59], v[108:111]
  ds_write_b128 v6, v[112:115] offset:0
  s_waitcnt vmcnt(7)
  v_mfma_f32_16x16x32_bf16 v[96:99], a[208:211], v[60:63], v[96:99]
  buffer_load_dwordx4 v[28:31], v236, s[52:55], s4 offen sc1
  s_add_u32 s4, s5, 2048
  v_mfma_f32_16x16x32_bf16 v[100:103], a[212:215], v[60:63], v[100:103]
  v_mfma_f32_16x16x32_bf16 v[104:107], a[216:219], v[60:63], v[104:107]
  v_mfma_f32_16x16x32_bf16 v[108:111], a[220:223], v[60:63], v[108:111]
  ds_write_b128 v6, v[116:119] offset:1024
  s_waitcnt vmcnt(7)
  v_mfma_f32_16x16x32_bf16 v[96:99], a[224:227], v[64:67], v[96:99]
  buffer_load_dwordx4 v[32:35], v237, s[52:55], s4 offen sc1
  s_add_u32 s4, s5, 6144
  v_mfma_f32_16x16x32_bf16 v[100:103], a[228:231], v[64:67], v[100:103]
  v_mfma_f32_16x16x32_bf16 v[104:107], a[232:235], v[64:67], v[104:107]
  v_mfma_f32_16x16x32_bf16 v[108:111], a[236:239], v[64:67], v[108:111]
  ds_write_b128 v6, v[120:123] offset:2048
  s_waitcnt vmcnt(7)
  v_mfma_f32_16x16x32_bf16 v[96:99], a[240:243], v[68:71], v[96:99]
  buffer_load_dwordx4 v[36:39], v237, s[52:55], s4 offen sc1
  s_add_u32 s4, s5, 10240
  v_mfma_f32_16x16x32_bf16 v[100:103], a[244:247], v[68:71], v[100:103]
  v_mfma_f32_16x16x32_bf16 v[104:107], a[248:251], v[68:71], v[104:107]
  v_mfma_f32_16x16x32_bf16 v[108:111], a[252:255], v[68:71], v[108:111]
  ds_write_b128 v6, v[124:127] offset:3072
  s_waitcnt vmcnt(7)
  v_mfma_f32_16x16x32_bf16 v[80:83], a[96:99], v[72:75], v[80:83]
  buffer_load_dwordx4 v[40:43], v237, s[52:55], s4 offen sc1
  s_add_u32 s4, s5, 14336
  v_mfma_f32_16x16x32_bf16 v[84:87], a[100:103], v[72:75], v[84:87]
  v_mfma_f32_16x16x32_bf16 v[88:91], a[104:107], v[72:75], v[88:91]
  v_mfma_f32_16x16x32_bf16 v[92:95], a[108:111], v[72:75], v[92:95]
  ds_write_b128 v5, v[96:99] offset:0
  s_waitcnt vmcnt(7)
  v_mfma_f32_16x16x32_bf16 v[80:83], a[112:115], v[76:79], v[80:83]
  buffer_load_dwordx4 v[44:47], v2, s[52:55], s4 offen sc1
  v_mfma_f32_16x16x32_bf16 v[84:87], a[116:119], v[76:79], v[84:87]
  v_mfma_f32_16x16x32_bf16 v[88:91], a[120:123], v[76:79], v[88:91]
  v_mfma_f32_16x16x32_bf16 v[92:95], a[124:127], v[76:79], v[92:95]
  ds_write_b128 v5, v[100:103] offset:1024
  s_waitcnt vmcnt(7)
  v_mfma_f32_16x16x32_bf16 v[80:83], a[128:131], v[16:19], v[80:83]
  v_mfma_f32_16x16x32_bf16 v[84:87], a[132:135], v[16:19], v[84:87]
  v_mfma_f32_16x16x32_bf16 v[88:91], a[136:139], v[16:19], v[88:91]
  v_mfma_f32_16x16x32_bf16 v[92:95], a[140:143], v[16:19], v[92:95]
  ds_write_b128 v5, v[104:107] offset:2048
  s_waitcnt vmcnt(6)
  v_mfma_f32_16x16x32_bf16 v[80:83], a[144:147], v[20:23], v[80:83]
  v_mfma_f32_16x16x32_bf16 v[84:87], a[148:151], v[20:23], v[84:87]
  v_mfma_f32_16x16x32_bf16 v[88:91], a[152:155], v[20:23], v[88:91]
  v_mfma_f32_16x16x32_bf16 v[92:95], a[156:159], v[20:23], v[92:95]
  ds_write_b128 v5, v[108:111] offset:3072
  s_waitcnt vmcnt(5)
  v_mfma_f32_16x16x32_bf16 v[80:83], a[160:163], v[24:27], v[80:83]
  v_mfma_f32_16x16x32_bf16 v[84:87], a[164:167], v[24:27], v[84:87]
  v_mfma_f32_16x16x32_bf16 v[88:91], a[168:171], v[24:27], v[88:91]
  v_mfma_f32_16x16x32_bf16 v[92:95], a[172:175], v[24:27], v[92:95]
  s_waitcnt vmcnt(4)
  s_waitcnt lgkmcnt(0)
  s_barrier
  v_mfma_f32_16x16x32_bf16 v[80:83], a[176:179], v[28:31], v[80:83]
  ds_read_b128 v[144:147], v8 offset:0
  v_mfma_f32_16x16x32_bf16 v[84:87], a[180:183], v[28:31], v[84:87]
  ds_read_b128 v[216:219], v8 offset:4096
  v_mfma_f32_16x16x32_bf16 v[88:91], a[184:187], v[28:31], v[88:91]
  ds_read_b128 v[200:203], v8 offset:8192
  v_mfma_f32_16x16x32_bf16 v[92:95], a[188:191], v[28:31], v[92:95]
  ds_read_b128 v[148:151], v8 offset:1024
  s_waitcnt vmcnt(3)
  v_mfma_f32_16x16x32_bf16 v[80:83], a[192:195], v[32:35], v[80:83]
  ds_read_b128 v[220:223], v8 offset:5120
  v_mfma_f32_16x16x32_bf16 v[84:87], a[196:199], v[32:35], v[84:87]
  ds_read_b128 v[204:207], v8 offset:9216
  v_mfma_f32_16x16x32_bf16 v[88:91], a[200:203], v[32:35], v[88:91]
  ds_read_b128 v[152:155], v8 offset:2048
  v_mfma_f32_16x16x32_bf16 v[92:95], a[204:207], v[32:35], v[92:95]
  ds_read_b128 v[224:227], v8 offset:6144
  s_waitcnt vmcnt(2)
  v_mfma_f32_16x16x32_bf16 v[80:83], a[208:211], v[36:39], v[80:83]
  ds_read_b128 v[208:211], v8 offset:10240
  v_mfma_f32_16x16x32_bf16 v[84:87], a[212:215], v[36:39], v[84:87]
  ds_read_b128 v[156:159], v8 offset:3072
  v_mfma_f32_16x16x32_bf16 v[88:91], a[216:219], v[36:39], v[88:91]
  ds_read_b128 v[228:231], v8 offset:7168
  v_mfma_f32_16x16x32_bf16 v[92:95], a[220:223], v[36:39], v[92:95]
  ds_read_b128 v[212:215], v8 offset:11264
  s_waitcnt vmcnt(1)
  v_mfma_f32_16x16x32_bf16 v[80:83], a[224:227], v[40:43], v[80:83]
  s_waitcnt lgkmcnt(9)
  v_add_f32 v144, v144, v216
  v_mfma_f32_16x16x32_bf16 v[84:87], a[228:231], v[40:43], v[84:87]
  v_add_f32 v145, v145, v217
  v_add_f32 v146, v146, v218
  v_mfma_f32_16x16x32_bf16 v[88:91], a[232:235], v[40:43], v[88:91]
  v_add_f32 v147, v147, v219
  v_add_f32 v144, v144, v200
  v_mfma_f32_16x16x32_bf16 v[92:95], a[236:239], v[40:43], v[92:95]
  v_add_f32 v145, v145, v201
  s_waitcnt vmcnt(0)
  v_mfma_f32_16x16x32_bf16 v[80:83], a[240:243], v[44:47], v[80:83]
  v_add_f32 v146, v146, v202
  v_add_f32 v147, v147, v203
  v_mfma_f32_16x16x32_bf16 v[84:87], a[244:247], v[44:47], v[84:87]
  v_fmac_f32 v184, v144, v160
  v_fmac_f32 v185, v145, v161
  v_mfma_f32_16x16x32_bf16 v[88:91], a[248:251], v[44:47], v[88:91]
  v_fmac_f32 v186, v146, v162
  v_fmac_f32 v187, v147, v163
  v_mfma_f32_16x16x32_bf16 v[92:95], a[252:255], v[44:47], v[92:95]
  s_waitcnt lgkmcnt(6)
  v_pk_add_f32 v[148:149], v[148:149], v[220:221]
  v_pk_add_f32 v[150:151], v[150:151], v[222:223]
  v_pk_add_f32 v[148:149], v[148:149], v[204:205]
  v_pk_add_f32 v[150:151], v[150:151], v[206:207]
  s_waitcnt lgkmcnt(3)
  v_pk_add_f32 v[152:153], v[152:153], v[224:225]
  v_pk_add_f32 v[154:155], v[154:155], v[226:227]
  v_pk_add_f32 v[152:153], v[152:153], v[208:209]
  v_pk_add_f32 v[154:155], v[154:155], v[210:211]
  s_waitcnt lgkmcnt(0)
  v_pk_add_f32 v[156:157], v[156:157], v[228:229]
  v_pk_add_f32 v[158:159], v[158:159], v[230:231]
  v_pk_add_f32 v[156:157], v[156:157], v[212:213]
  v_pk_add_f32 v[158:159], v[158:159], v[214:215]
  v_pk_add_f32 v[84:85], v[84:85], v[148:149]
  v_pk_add_f32 v[86:87], v[86:87], v[150:151]
  v_pk_add_f32 v[88:89], v[88:89], v[152:153]
  v_pk_add_f32 v[90:91], v[90:91], v[154:155]
  v_pk_add_f32 v[92:93], v[92:93], v[156:157]
  v_pk_add_f32 v[94:95], v[94:95], v[158:159]
  v_pk_fma_f32 v[184:185], v[80:81], v[160:161], v[184:185]
  v_pk_fma_f32 v[186:187], v[82:83], v[162:163], v[186:187]
  v_cvt_pk_bf16_f32 v240, v184, v185
  v_cvt_pk_bf16_f32 v241, v186, v187
  v_pk_fma_f32 v[188:189], v[84:85], v[164:165], v[188:189]
  v_pk_fma_f32 v[190:191], v[86:87], v[166:167], v[190:191]
  v_cvt_pk_bf16_f32 v242, v188, v189
  v_cvt_pk_bf16_f32 v243, v190, v191
  ds_write2_b64 v180, v[240:241], v[242:243] offset0:0 offset1:4
  v_pk_fma_f32 v[192:193], v[88:89], v[168:169], v[192:193]
  v_pk_fma_f32 v[194:195], v[90:91], v[170:171], v[194:195]
  v_cvt_pk_bf16_f32 v244, v192, v193
  v_cvt_pk_bf16_f32 v245, v194, v195
  v_pk_fma_f32 v[196:197], v[92:93], v[172:173], v[196:197]
  v_pk_fma_f32 v[198:199], v[94:95], v[174:175], v[198:199]
  v_cvt_pk_bf16_f32 v246, v196, v197
  v_cvt_pk_bf16_f32 v247, v198, v199
  ds_write2_b64 v180, v[244:245], v[246:247] offset0:8 offset1:12
  ds_read_b128 v[144:147], v181 offset:0
  ds_read_b128 v[148:151], v181 offset:1152
  s_waitcnt lgkmcnt(1)
  buffer_store_dwordx4 v[144:147], v177, s[56:59], s21 offen nt
  s_waitcnt lgkmcnt(0)
  buffer_store_dwordx4 v[148:151], v177, s[56:59], s3 offen nt
L_end:
  s_endpgm
L_hot_end:
L_redo_18:
  s_waitcnt vmcnt(0)
  v_lshrrev_b32 v4, 5, v1
  v_and_b32 v3, 15, v1
  v_lshl_add_u32 v3, v4, 4, v3
  v_lshlrev_b32 v15, 4, v3
  v_mov_b32 v112, 0x3f803f80
  v_mov_b32 v113, 0x3f803f80
  v_mov_b32 v114, 0x3f803f80
  v_mov_b32 v115, 0x3f803f80
  v_mov_b32 v116, 0x3f803f80
  v_mov_b32 v117, 0x3f803f80
  v_mov_b32 v118, 0x3f803f80
  v_mov_b32 v119, 0x3f803f80
  v_mov_b32 v120, 0x3f803f80
  v_mov_b32 v121, 0x3f803f80
  v_mov_b32 v122, 0x3f803f80
  v_mov_b32 v123, 0x3f803f80
  v_mov_b32 v124, 0x3f803f80
  v_mov_b32 v125, 0x3f803f80
  v_mov_b32 v126, 0x3f803f80
  v_mov_b32 v127, 0x3f803f80
  v_mov_b32 v128, 0x3f803f80
  v_mov_b32 v129, 0x3f803f80
  v_mov_b32 v130, 0x3f803f80
  v_mov_b32 v131, 0x3f803f80
  v_mov_b32 v132, 0x3f803f80
  v_mov_b32 v133, 0x3f803f80
  v_mov_b32 v134, 0x3f803f80
  v_mov_b32 v135, 0x3f803f80
  v_mov_b32 v136, 0x3f803f80
  v_mov_b32 v137, 0x3f803f80
  v_mov_b32 v138, 0x3f803f80
  v_mov_b32 v139, 0x3f803f80
  v_mov_b32 v140, 0x3f803f80
  v_mov_b32 v141, 0x3f803f80
  v_mov_b32 v142, 0x3f803f80
  v_mov_b32 v143, 0x3f803f80
  s_cmp_ge_u32 s61, 1
  s_cselect_b32 s34, 0x1000000, 0
  s_sub_u32 s3, s12, 4096
  buffer_load_dwordx4 v[76:79], v2, s[32:35], s3 offen offset:2048 sc1
  buffer_load_dwordx4 v[72:75], v2, s[32:35], s3 offen offset:0 sc1
  s_mov_b64 exec, s[8:9]
  buffer_load_dwordx4 v[136:139], v15, s[32:35], s3 offen offset:3072 sc1
  buffer_load_dwordx4 v[140:143], v15, s[32:35], s3 offen offset:3584 sc1
  buffer_load_dwordx4 v[128:131], v15, s[32:35], s3 offen offset:1024 sc1
  buffer_load_dwordx4 v[132:135], v15, s[32:35], s3 offen offset:1536 sc1
  s_mov_b64 exec, -1
  s_cmp_ge_u32 s61, 2
  s_cselect_b32 s34, 0x1000000, 0
  s_sub_u32 s3, s12, 8192
  buffer_load_dwordx4 v[68:71], v2, s[32:35], s3 offen offset:2048 sc1
  buffer_load_dwordx4 v[64:67], v2, s[32:35], s3 offen offset:0 sc1
  s_mov_b64 exec, s[8:9]
  buffer_load_dwordx4 v[120:123], v15, s[32:35], s3 offen offset:3072 sc1
  buffer_load_dwordx4 v[124:127], v15, s[32:35], s3 offen offset:3584 sc1
  buffer_load_dwordx4 v[112:115], v15, s[32:35], s3 offen offset:1024 sc1
  buffer_load_dwordx4 v[116:119], v15, s[32:35], s3 offen offset:1536 sc1
  s_mov_b64 exec, -1
  s_waitcnt vmcnt(0)
  v_mov_b32 v3, 0xff7fffff
  v_mov_b32 v4, 0xff7fffff
  v_mfma_f32_32x32x16_bf16 v[144:159], v[24:27], v[16:19], v[192:207]
  s_nop 11
  v_max3_f32 v3, v3, v144, v145
  v_max3_f32 v3, v3, v146, v147
  v_max3_f32 v3, v3, v148, v149
  v_max3_f32 v3, v3, v150, v151
  v_max3_f32 v3, v3, v152, v153
  v_max3_f32 v3, v3, v154, v155
  v_max3_f32 v3, v3, v156, v157
  v_max3_f32 v3, v3, v158, v159
  v_mfma_f32_32x32x16_bf16 v[144:159], v[24:27], v[20:23], 0
  s_nop 11
  v_max3_f32 v4, v4, v144, v145
  v_max3_f32 v4, v4, v146, v147
  v_max3_f32 v4, v4, v148, v149
  v_max3_f32 v4, v4, v150, v151
  v_max3_f32 v4, v4, v152, v153
  v_max3_f32 v4, v4, v154, v155
  v_max3_f32 v4, v4, v156, v157
  v_max3_f32 v4, v4, v158, v159
  v_mfma_f32_32x32x16_bf16 v[144:159], v[28:31], v[20:23], v[192:207]
  s_nop 11
  v_max3_f32 v4, v4, v144, v145
  v_max3_f32 v4, v4, v146, v147
  v_max3_f32 v4, v4, v148, v149
  v_max3_f32 v4, v4, v150, v151
  v_max3_f32 v4, v4, v152, v153
  v_max3_f32 v4, v4, v154, v155
  v_max3_f32 v4, v4, v156, v157
  v_max3_f32 v4, v4, v158, v159
  s_cmp_lt_u32 s61, 1
  s_cbranch_scc1 L_mxend_100001
  v_mfma_f32_32x32x16_bf16 v[144:159], v[76:79], v[16:19], 0
  s_nop 11
  v_max3_f32 v3, v3, v144, v145
  v_max3_f32 v3, v3, v146, v147
  v_max3_f32 v3, v3, v148, v149
  v_max3_f32 v3, v3, v150, v151
  v_max3_f32 v3, v3, v152, v153
  v_max3_f32 v3, v3, v154, v155
  v_max3_f32 v3, v3, v156, v157
  v_max3_f32 v3, v3, v158, v159
  v_mfma_f32_32x32x16_bf16 v[144:159], v[76:79], v[20:23], 0
  s_nop 11
  v_max3_f32 v4, v4, v144, v145
  v_max3_f32 v4, v4, v146, v147
  v_max3_f32 v4, v4, v148, v149
  v_max3_f32 v4, v4, v150, v151
  v_max3_f32 v4, v4, v152, v153
  v_max3_f32 v4, v4, v154, v155
  v_max3_f32 v4, v4, v156, v157
  v_max3_f32 v4, v4, v158, v159
  v_mfma_f32_32x32x16_bf16 v[144:159], v[72:75], v[16:19], 0
  s_nop 11
  v_max3_f32 v3, v3, v144, v145
  v_max3_f32 v3, v3, v146, v147
  v_max3_f32 v3, v3, v148, v149
  v_max3_f32 v3, v3, v150, v151
  v_max3_f32 v3, v3, v152, v153
  v_max3_f32 v3, v3, v154, v155
  v_max3_f32 v3, v3, v156, v157
  v_max3_f32 v3, v3, v158, v159
  v_mfma_f32_32x32x16_bf16 v[144:159], v[72:75], v[20:23], 0
  s_nop 11
  v_max3_f32 v4, v4, v144, v145
  v_max3_f32 v4, v4, v146, v147
  v_max3_f32 v4, v4, v148, v149
  v_max3_f32 v4, v4, v150, v151
  v_max3_f32 v4, v4, v152, v153
  v_max3_f32 v4, v4, v154, v155
  v_max3_f32 v4, v4, v156, v157
  v_max3_f32 v4, v4, v158, v159
  s_cmp_lt_u32 s61, 2
  s_cbranch_scc1 L_mxend_100001
  v_mfma_f32_32x32x16_bf16 v[144:159], v[68:71], v[16:19], 0
  s_nop 11
  v_max3_f32 v3, v3, v144, v145
  v_max3_f32 v3, v3, v146, v147
  v_max3_f32 v3, v3, v148, v149
  v_max3_f32 v3, v3, v150, v151
  v_max3_f32 v3, v3, v152, v153
  v_max3_f32 v3, v3, v154, v155
  v_max3_f32 v3, v3, v156, v157
  v_max3_f32 v3, v3, v158, v159
  v_mfma_f32_32x32x16_bf16 v[144:159], v[68:71], v[20:23], 0
  s_nop 11
  v_max3_f32 v4, v4, v144, v145
  v_max3_f32 v4, v4, v146, v147
  v_max3_f32 v4, v4, v148, v149
  v_max3_f32 v4, v4, v150, v151
  v_max3_f32 v4, v4, v152, v153
  v_max3_f32 v4, v4, v154, v155
  v_max3_f32 v4, v4, v156, v157
  v_max3_f32 v4, v4, v158, v159
  v_mfma_f32_32x32x16_bf16 v[144:159], v[64:67], v[16:19], 0
  s_nop 11
  v_max3_f32 v3, v3, v144, v145
  v_max3_f32 v3, v3, v146, v147
  v_max3_f32 v3, v3, v148, v149
  v_max3_f32 v3, v3, v150, v151
  v_max3_f32 v3, v3, v152, v153
  v_max3_f32 v3, v3, v154, v155
  v_max3_f32 v3, v3, v156, v157
  v_max3_f32 v3, v3, v158, v159
  v_mfma_f32_32x32x16_bf16 v[144:159], v[64:67], v[20:23], 0
  s_nop 11
  v_max3_f32 v4, v4, v144, v145
  v_max3_f32 v4, v4, v146, v147
  v_max3_f32 v4, v4, v148, v149
  v_max3_f32 v4, v4, v150, v151
  v_max3_f32 v4, v4, v152, v153
  v_max3_f32 v4, v4, v154, v155
  v_max3_f32 v4, v4, v156, v157
  v_max3_f32 v4, v4, v158, v159
  s_cmp_lt_u32 s61, 3
  s_cbranch_scc1 L_mxend_100001
  v_mfma_f32_32x32x16_bf16 v[144:159], v[60:63], v[16:19], 0
  s_nop 11
  v_max3_f32 v3, v3, v144, v145
  v_max3_f32 v3, v3, v146, v147
  v_max3_f32 v3, v3, v148, v149
  v_max3_f32 v3, v3, v150, v151
  v_max3_f32 v3, v3, v152, v153
  v_max3_f32 v3, v3, v154, v155
  v_max3_f32 v3, v3, v156, v157
  v_max3_f32 v3, v3, v158, v159
  v_mfma_f32_32x32x16_bf16 v[144:159], v[60:63], v[20:23], 0
  s_nop 11
  v_max3_f32 v4, v4, v144, v145
  v_max3_f32 v4, v4, v146, v147
  v_max3_f32 v4, v4, v148, v149
  v_max3_f32 v4, v4, v150, v151
  v_max3_f32 v4, v4, v152, v153
  v_max3_f32 v4, v4, v154, v155
  v_max3_f32 v4, v4, v156, v157
  v_max3_f32 v4, v4, v158, v159
  v_mfma_f32_32x32x16_bf16 v[144:159], v[56:59], v[16:19], 0
  s_nop 11
  v_max3_f32 v3, v3, v144, v145
  v_max3_f32 v3, v3, v146, v147
  v_max3_f32 v3, v3, v148, v149
  v_max3_f32 v3, v3, v150, v151
  v_max3_f32 v3, v3, v152, v153
  v_max3_f32 v3, v3, v154, v155
  v_max3_f32 v3, v3, v156, v157
  v_max3_f32 v3, v3, v158, v159
  v_mfma_f32_32x32x16_bf16 v[144:159], v[56:59], v[20:23], 0
  s_nop 11
  v_max3_f32 v4, v4, v144, v145
  v_max3_f32 v4, v4, v146, v147
  v_max3_f32 v4, v4, v148, v149
  v_max3_f32 v4, v4, v150, v151
  v_max3_f32 v4, v4, v152, v153
  v_max3_f32 v4, v4, v154, v155
  v_max3_f32 v4, v4, v156, v157
  v_max3_f32 v4, v4, v158, v159
  s_cmp_lt_u32 s61, 4
  s_cbranch_scc1 L_mxend_100001
  v_mfma_f32_32x32x16_bf16 v[144:159], v[52:55], v[16:19], 0
  s_nop 11
  v_max3_f32 v3, v3, v144, v145
  v_max3_f32 v3, v3, v146, v147
  v_max3_f32 v3, v3, v148, v149
  v_max3_f32 v3, v3, v150, v151
  v_max3_f32 v3, v3, v152, v153
  v_max3_f32 v3, v3, v154, v155
  v_max3_f32 v3, v3, v156, v157
  v_max3_f32 v3, v3, v158, v159
  v_mfma_f32_32x32x16_bf16 v[144:159], v[52:55], v[20:23], v[208:223]
  s_nop 11
  v_max3_f32 v4, v4, v144, v145
  v_max3_f32 v4, v4, v146, v147
  v_max3_f32 v4, v4, v148, v149
  v_max3_f32 v4, v4, v150, v151
  v_max3_f32 v4, v4, v152, v153
  v_max3_f32 v4, v4, v154, v155
  v_max3_f32 v4, v4, v156, v157
  v_max3_f32 v4, v4, v158, v159
  v_mfma_f32_32x32x16_bf16 v[144:159], v[48:51], v[16:19], v[208:223]
  s_nop 11
  v_max3_f32 v3, v3, v144, v145
  v_max3_f32 v3, v3, v146, v147
  v_max3_f32 v3, v3, v148, v149
  v_max3_f32 v3, v3, v150, v151
  v_max3_f32 v3, v3, v152, v153
  v_max3_f32 v3, v3, v154, v155
  v_max3_f32 v3, v3, v156, v157
  v_max3_f32 v3, v3, v158, v159
L_mxend_100001:
  v_mov_b32 v144, v3
  s_nop 1
  v_permlane32_swap_b32 v144, v3
  v_max_f32 v3, v144, v3
  v_mov_b32 v144, v4
  s_nop 1
  v_permlane32_swap_b32 v144, v4
  v_max_f32 v4, v144, v4
  v_mfma_f32_32x32x16_bf16 v[144:159], v[24:27], v[16:19], v[192:207]
  s_nop 11
  v_sub_f32 v144, v144, v3
  v_sub_f32 v145, v145, v3
  v_sub_f32 v146, v146, v3
  v_sub_f32 v147, v147, v3
  v_sub_f32 v148, v148, v3
  v_sub_f32 v149, v149, v3
  v_sub_f32 v150, v150, v3
  v_sub_f32 v151, v151, v3
  v_exp_f32 v144, v144
  v_exp_f32 v145, v145
  v_exp_f32 v146, v146
  v_cvt_pk_bf16_f32 v176, v144, v145
  v_exp_f32 v147, v147
  v_exp_f32 v148, v148
  v_cvt_pk_bf16_f32 v177, v146, v147
  v_exp_f32 v149, v149
  v_mfma_f32_32x32x16_bf16 v[160:175], v[24:27], v[20:23], 0
  v_exp_f32 v150, v150
  v_cvt_pk_bf16_f32 v178, v148, v149
  v_exp_f32 v151, v151
  v_sub_f32 v152, v152, v3
  v_sub_f32 v153, v153, v3
  v_sub_f32 v154, v154, v3
  v_sub_f32 v155, v155, v3
  v_sub_f32 v156, v156, v3
  v_sub_f32 v157, v157, v3
  v_sub_f32 v158, v158, v3
  v_sub_f32 v159, v159, v3
  v_exp_f32 v152, v152
  v_cvt_pk_bf16_f32 v179, v150, v151
  v_exp_f32 v153, v153
  v_exp_f32 v154, v154
  v_mfma_f32_32x32x16_bf16 v[224:239], v[32:35], v[176:179], 0
  v_cvt_pk_bf16_f32 v180, v152, v153
  v_exp_f32 v155, v155
  v_exp_f32 v156, v156
  v_cvt_pk_bf16_f32 v181, v154, v155
  v_exp_f32 v157, v157
  v_exp_f32 v158, v158
  v_cvt_pk_bf16_f32 v182, v156, v157
  v_exp_f32 v159, v159
  v_sub_f32 v160, v160, v4
  v_sub_f32 v161, v161, v4
  v_sub_f32 v162, v162, v4
  v_sub_f32 v163, v163, v4
  v_sub_f32 v164, v164, v4
  v_sub_f32 v165, v165, v4
  v_sub_f32 v166, v166, v4
  v_sub_f32 v167, v167, v4
  v_exp_f32 v160, v160
  v_cvt_pk_bf16_f32 v183, v158, v159
  v_exp_f32 v161, v161
  v_exp_f32 v162, v162
  v_mfma_f32_32x32x16_bf16 v[224:239], v[36:39], v[180:183], v[224:239]
  v_cvt_pk_bf16_f32 v184, v160, v161
  v_exp_f32 v163, v163
  v_exp_f32 v164, v164
  v_cvt_pk_bf16_f32 v185, v162, v163
  v_exp_f32 v165, v165
  v_mfma_f32_32x32x16_bf16 v[144:159], v[28:31], v[20:23], v[192:207]
  v_exp_f32 v166, v166
  v_cvt_pk_bf16_f32 v186, v164, v165
  v_exp_f32 v167, v167
  v_sub_f32 v168, v168, v4
  v_sub_f32 v169, v169, v4
  v_sub_f32 v170, v170, v4
  v_sub_f32 v171, v171, v4
  v_sub_f32 v172, v172, v4
  v_sub_f32 v173, v173, v4
  v_sub_f32 v174, v174, v4
  v_sub_f32 v175, v175, v4
  v_exp_f32 v168, v168
  v_cvt_pk_bf16_f32 v187, v166, v167
  v_exp_f32 v169, v169
  v_exp_f32 v170, v170
  v_mfma_f32_32x32x16_bf16 v[240:255], v[32:35], v[184:187], 0
  v_cvt_pk_bf16_f32 v188, v168, v169
  v_exp_f32 v171, v171
  v_exp_f32 v172, v172
  v_cvt_pk_bf16_f32 v189, v170, v171
  v_exp_f32 v173, v173
  v_exp_f32 v174, v174
  v_cvt_pk_bf16_f32 v190, v172, v173
  v_exp_f32 v175, v175
  v_sub_f32 v144, v144, v4
  v_sub_f32 v145, v145, v4
  v_sub_f32 v146, v146, v4
  v_sub_f32 v147, v147, v4
  v_sub_f32 v148, v148, v4
  v_sub_f32 v149, v149, v4
  v_sub_f32 v150, v150, v4
  v_sub_f32 v151, v151, v4
  v_exp_f32 v144, v144
  v_cvt_pk_bf16_f32 v191, v174, v175
  v_exp_f32 v145, v145
  v_exp_f32 v146, v146
  v_mfma_f32_32x32x16_bf16 v[240:255], v[36:39], v[188:191], v[240:255]
  v_cvt_pk_bf16_f32 v176, v144, v145
  v_exp_f32 v147, v147
  v_exp_f32 v148, v148
  v_cvt_pk_bf16_f32 v177, v146, v147
  v_exp_f32 v149, v149
  v_exp_f32 v150, v150
  v_cvt_pk_bf16_f32 v178, v148, v149
  v_exp_f32 v151, v151
  v_sub_f32 v152, v152, v4
  v_sub_f32 v153, v153, v4
  v_sub_f32 v154, v154, v4
  v_sub_f32 v155, v155, v4
  v_sub_f32 v156, v156, v4
  v_sub_f32 v157, v157, v4
  v_sub_f32 v158, v158, v4
  v_sub_f32 v159, v159, v4
  v_exp_f32 v152, v152
  v_cvt_pk_bf16_f32 v179, v150, v151
  v_exp_f32 v153, v153
  v_exp_f32 v154, v154
  v_mfma_f32_32x32x16_bf16 v[240:255], v[40:43], v[176:179], v[240:255]
  v_cvt_pk_bf16_f32 v180, v152, v153
  v_exp_f32 v155, v155
  v_exp_f32 v156, v156
  v_cvt_pk_bf16_f32 v181, v154, v155
  v_exp_f32 v157, v157
  v_exp_f32 v158, v158
  v_cvt_pk_bf16_f32 v182, v156, v157
  v_exp_f32 v159, v159
  s_nop 0
  v_cvt_pk_bf16_f32 v183, v158, v159
  s_nop 1
  v_mfma_f32_32x32x16_bf16 v[240:255], v[44:47], v[180:183], v[240:255]
  s_cmp_lt_u32 s61, 1
  s_cbranch_scc1 L_p2end_100002
  v_mfma_f32_32x32x16_bf16 v[144:159], v[76:79], v[16:19], 0
  s_nop 11
  v_sub_f32 v144, v144, v3
  v_sub_f32 v145, v145, v3
  v_sub_f32 v146, v146, v3
  v_sub_f32 v147, v147, v3
  v_sub_f32 v148, v148, v3
  v_sub_f32 v149, v149, v3
  v_sub_f32 v150, v150, v3
  v_sub_f32 v151, v151, v3
  v_exp_f32 v144, v144
  v_exp_f32 v145, v145
  v_exp_f32 v146, v146
  v_cvt_pk_bf16_f32 v176, v144, v145
  v_exp_f32 v147, v147
  v_exp_f32 v148, v148
  v_cvt_pk_bf16_f32 v177, v146, v147
  v_exp_f32 v149, v149
  v_mfma_f32_32x32x16_bf16 v[160:175], v[76:79], v[20:23], 0
  v_exp_f32 v150, v150
  v_cvt_pk_bf16_f32 v178, v148, v149
  v_exp_f32 v151, v151
  v_sub_f32 v152, v152, v3
  v_sub_f32 v153, v153, v3
  v_sub_f32 v154, v154, v3
  v_sub_f32 v155, v155, v3
  v_sub_f32 v156, v156, v3
  v_sub_f32 v157, v157, v3
  v_sub_f32 v158, v158, v3
  v_sub_f32 v159, v159, v3
  v_exp_f32 v152, v152
  v_cvt_pk_bf16_f32 v179, v150, v151
  v_exp_f32 v153, v153
  v_exp_f32 v154, v154
  v_mfma_f32_32x32x16_bf16 v[224:239], v[136:139], v[176:179], v[224:239]
  v_cvt_pk_bf16_f32 v180, v152, v153
  v_exp_f32 v155, v155
  v_exp_f32 v156, v156
  v_cvt_pk_bf16_f32 v181, v154, v155
  v_exp_f32 v157, v157
  v_exp_f32 v158, v158
  v_cvt_pk_bf16_f32 v182, v156, v157
  v_exp_f32 v159, v159
  v_sub_f32 v160, v160, v4
  v_sub_f32 v161, v161, v4
  v_sub_f32 v162, v162, v4
  v_sub_f32 v163, v163, v4
  v_sub_f32 v164, v164, v4
  v_sub_f32 v165, v165, v4
  v_sub_f32 v166, v166, v4
  v_sub_f32 v167, v167, v4
  v_exp_f32 v160, v160
  v_cvt_pk_bf16_f32 v183, v158, v159
  v_exp_f32 v161, v161
  v_exp_f32 v162, v162
  v_mfma_f32_32x32x16_bf16 v[224:239], v[140:143], v[180:183], v[224:239]
  v_cvt_pk_bf16_f32 v184, v160, v161
  v_exp_f32 v163, v163
  v_exp_f32 v164, v164
  v_cvt_pk_bf16_f32 v185, v162, v163
  v_exp_f32 v165, v165
  v_mfma_f32_32x32x16_bf16 v[144:159], v[72:75], v[16:19], 0
  v_exp_f32 v166, v166
  v_cvt_pk_bf16_f32 v186, v164, v165
  v_exp_f32 v167, v167
  v_sub_f32 v168, v168, v4
  v_sub_f32 v169, v169, v4
  v_sub_f32 v170, v170, v4
  v_sub_f32 v171, v171, v4
  v_sub_f32 v172, v172, v4
  v_sub_f32 v173, v173, v4
  v_sub_f32 v174, v174, v4
  v_sub_f32 v175, v175, v4
  v_exp_f32 v168, v168
  v_cvt_pk_bf16_f32 v187, v166, v167
  v_exp_f32 v169, v169
  v_exp_f32 v170, v170
  v_mfma_f32_32x32x16_bf16 v[240:255], v[136:139], v[184:187], v[240:255]
  v_cvt_pk_bf16_f32 v188, v168, v169
  v_exp_f32 v171, v171
  v_exp_f32 v172, v172
  v_cvt_pk_bf16_f32 v189, v170, v171
  v_exp_f32 v173, v173
  v_exp_f32 v174, v174
  v_cvt_pk_bf16_f32 v190, v172, v173
  v_exp_f32 v175, v175
  v_sub_f32 v144, v144, v3
  v_sub_f32 v145, v145, v3
  v_sub_f32 v146, v146, v3
  v_sub_f32 v147, v147, v3
  v_sub_f32 v148, v148, v3
  v_sub_f32 v149, v149, v3
  v_sub_f32 v150, v150, v3
  v_sub_f32 v151, v151, v3
  v_exp_f32 v144, v144
  v_cvt_pk_bf16_f32 v191, v174, v175
  v_exp_f32 v145, v145
  v_exp_f32 v146, v146
  v_mfma_f32_32x32x16_bf16 v[240:255], v[140:143], v[188:191], v[240:255]
  v_cvt_pk_bf16_f32 v176, v144, v145
  v_exp_f32 v147, v147
  v_exp_f32 v148, v148
  v_cvt_pk_bf16_f32 v177, v146, v147
  v_exp_f32 v149, v149
  v_mfma_f32_32x32x16_bf16 v[160:175], v[72:75], v[20:23], 0
  v_exp_f32 v150, v150
  v_cvt_pk_bf16_f32 v178, v148, v149
  v_exp_f32 v151, v151
  v_sub_f32 v152, v152, v3
  v_sub_f32 v153, v153, v3
  v_sub_f32 v154, v154, v3
  v_sub_f32 v155, v155, v3
  v_sub_f32 v156, v156, v3
  v_sub_f32 v157, v157, v3
  v_sub_f32 v158, v158, v3
  v_sub_f32 v159, v159, v3
  v_exp_f32 v152, v152
  v_cvt_pk_bf16_f32 v179, v150, v151
  v_exp_f32 v153, v153
  v_exp_f32 v154, v154
  v_mfma_f32_32x32x16_bf16 v[224:239], v[128:131], v[176:179], v[224:239]
  v_cvt_pk_bf16_f32 v180, v152, v153
  v_exp_f32 v155, v155
  v_exp_f32 v156, v156
  v_cvt_pk_bf16_f32 v181, v154, v155
  v_exp_f32 v157, v157
  v_exp_f32 v158, v158
  v_cvt_pk_bf16_f32 v182, v156, v157
  v_exp_f32 v159, v159
  v_sub_f32 v160, v160, v4
  v_sub_f32 v161, v161, v4
  v_sub_f32 v162, v162, v4
  v_sub_f32 v163, v163, v4
  v_sub_f32 v164, v164, v4
  v_sub_f32 v165, v165, v4
  v_sub_f32 v166, v166, v4
  v_sub_f32 v167, v167, v4
  v_exp_f32 v160, v160
  v_cvt_pk_bf16_f32 v183, v158, v159
  v_exp_f32 v161, v161
  v_exp_f32 v162, v162
  v_mfma_f32_32x32x16_bf16 v[224:239], v[132:135], v[180:183], v[224:239]
  v_cvt_pk_bf16_f32 v184, v160, v161
  v_exp_f32 v163, v163
  v_exp_f32 v164, v164
  v_cvt_pk_bf16_f32 v185, v162, v163
  v_exp_f32 v165, v165
  v_exp_f32 v166, v166
  v_cvt_pk_bf16_f32 v186, v164, v165
  v_exp_f32 v167, v167
  v_sub_f32 v168, v168, v4
  v_sub_f32 v169, v169, v4
  v_sub_f32 v170, v170, v4
  v_sub_f32 v171, v171, v4
  v_sub_f32 v172, v172, v4
  v_sub_f32 v173, v173, v4
  v_sub_f32 v174, v174, v4
  v_sub_f32 v175, v175, v4
  v_exp_f32 v168, v168
  v_cvt_pk_bf16_f32 v187, v166, v167
  v_exp_f32 v169, v169
  v_exp_f32 v170, v170
  v_mfma_f32_32x32x16_bf16 v[240:255], v[128:131], v[184:187], v[240:255]
  v_cvt_pk_bf16_f32 v188, v168, v169
  v_exp_f32 v171, v171
  v_exp_f32 v172, v172
  v_cvt_pk_bf16_f32 v189, v170, v171
  v_exp_f32 v173, v173
  v_exp_f32 v174, v174
  v_cvt_pk_bf16_f32 v190, v172, v173
  v_exp_f32 v175, v175
  s_nop 0
  v_cvt_pk_bf16_f32 v191, v174, v175
  s_nop 1
  v_mfma_f32_32x32x16_bf16 v[240:255], v[132:135], v[188:191], v[240:255]
  s_cmp_lt_u32 s61, 2
  s_cbranch_scc1 L_p2end_100002
  v_mfma_f32_32x32x16_bf16 v[144:159], v[68:71], v[16:19], 0
  s_nop 11
  v_sub_f32 v144, v144, v3
  v_sub_f32 v145, v145, v3
  v_sub_f32 v146, v146, v3
  v_sub_f32 v147, v147, v3
  v_sub_f32 v148, v148, v3
  v_sub_f32 v149, v149, v3
  v_sub_f32 v150, v150, v3
  v_sub_f32 v151, v151, v3
  v_exp_f32 v144, v144
  v_exp_f32 v145, v145
  v_exp_f32 v146, v146
  v_cvt_pk_bf16_f32 v176, v144, v145
  v_exp_f32 v147, v147
  v_exp_f32 v148, v148
  v_cvt_pk_bf16_f32 v177, v146, v147
  v_exp_f32 v149, v149
  v_mfma_f32_32x32x16_bf16 v[160:175], v[68:71], v[20:23], 0
  v_exp_f32 v150, v150
  v_cvt_pk_bf16_f32 v178, v148, v149
  v_exp_f32 v151, v151
  v_sub_f32 v152, v152, v3
  v_sub_f32 v153, v153, v3
  v_sub_f32 v154, v154, v3
  v_sub_f32 v155, v155, v3
  v_sub_f32 v156, v156, v3
  v_sub_f32 v157, v157, v3
  v_sub_f32 v158, v158, v3
  v_sub_f32 v159, v159, v3
  v_exp_f32 v152, v152
  v_cvt_pk_bf16_f32 v179, v150, v151
  v_exp_f32 v153, v153
  v_exp_f32 v154, v154
  v_mfma_f32_32x32x16_bf16 v[224:239], v[120:123], v[176:179], v[224:239]
  v_cvt_pk_bf16_f32 v180, v152, v153
  v_exp_f32 v155, v155
  v_exp_f32 v156, v156
  v_cvt_pk_bf16_f32 v181, v154, v155
  v_exp_f32 v157, v157
  v_exp_f32 v158, v158
  v_cvt_pk_bf16_f32 v182, v156, v157
  v_exp_f32 v159, v159
  v_sub_f32 v160, v160, v4
  v_sub_f32 v161, v161, v4
  v_sub_f32 v162, v162, v4
  v_sub_f32 v163, v163, v4
  v_sub_f32 v164, v164, v4
  v_sub_f32 v165, v165, v4
  v_sub_f32 v166, v166, v4
  v_sub_f32 v167, v167, v4
  v_exp_f32 v160, v160
  v_cvt_pk_bf16_f32 v183, v158, v159
  v_exp_f32 v161, v161
  v_exp_f32 v162, v162
  v_mfma_f32_32x32x16_bf16 v[224:239], v[124:127], v[180:183], v[224:239]
  v_cvt_pk_bf16_f32 v184, v160, v161
  v_exp_f32 v163, v163
  v_exp_f32 v164, v164
  v_cvt_pk_bf16_f32 v185, v162, v163
  v_exp_f32 v165, v165
  v_mfma_f32_32x32x16_bf16 v[144:159], v[64:67], v[16:19], 0
  v_exp_f32 v166, v166
  v_cvt_pk_bf16_f32 v186, v164, v165
  v_exp_f32 v167, v167
  v_sub_f32 v168, v168, v4
  v_sub_f32 v169, v169, v4
  v_sub_f32 v170, v170, v4
  v_sub_f32 v171, v171, v4
  v_sub_f32 v172, v172, v4
  v_sub_f32 v173, v173, v4
  v_sub_f32 v174, v174, v4
  v_sub_f32 v175, v175, v4
  v_exp_f32 v168, v168
  v_cvt_pk_bf16_f32 v187, v166, v167
  v_exp_f32 v169, v169
  v_exp_f32 v170, v170
  v_mfma_f32_32x32x16_bf16 v[240:255], v[120:123], v[184:187], v[240:255]
  v_cvt_pk_bf16_f32 v188, v168, v169
  v_exp_f32 v171, v171
  v_exp_f32 v172, v172
  v_cvt_pk_bf16_f32 v189, v170, v171
  v_exp_f32 v173, v173
  v_exp_f32 v174, v174
  v_cvt_pk_bf16_f32 v190, v172, v173
  v_exp_f32 v175, v175
  v_sub_f32 v144, v144, v3
  v_sub_f32 v145, v145, v3
  v_sub_f32 v146, v146, v3
  v_sub_f32 v147, v147, v3
  v_sub_f32 v148, v148, v3
  v_sub_f32 v149, v149, v3
  v_sub_f32 v150, v150, v3
  v_sub_f32 v151, v151, v3
  v_exp_f32 v144, v144
  v_cvt_pk_bf16_f32 v191, v174, v175
  v_exp_f32 v145, v145
  v_exp_f32 v146, v146
  v_mfma_f32_32x32x16_bf16 v[240:255], v[124:127], v[188:191], v[240:255]
  v_cvt_pk_bf16_f32 v176, v144, v145
  v_exp_f32 v147, v147
  v_exp_f32 v148, v148
  v_cvt_pk_bf16_f32 v177, v146, v147
  v_exp_f32 v149, v149
  v_mfma_f32_32x32x16_bf16 v[160:175], v[64:67], v[20:23], 0
  v_exp_f32 v150, v150
  v_cvt_pk_bf16_f32 v178, v148, v149
  v_exp_f32 v151, v151
  v_sub_f32 v152, v152, v3
  v_sub_f32 v153, v153, v3
  v_sub_f32 v154, v154, v3
  v_sub_f32 v155, v155, v3
  v_sub_f32 v156, v156, v3
  v_sub_f32 v157, v157, v3
  v_sub_f32 v158, v158, v3
  v_sub_f32 v159, v159, v3
  v_exp_f32 v152, v152
  v_cvt_pk_bf16_f32 v179, v150, v151
  v_exp_f32 v153, v153
  v_exp_f32 v154, v154
  v_mfma_f32_32x32x16_bf16 v[224:239], v[112:115], v[176:179], v[224:239]
  v_cvt_pk_bf16_f32 v180, v152, v153
  v_exp_f32 v155, v155
  v_exp_f32 v156, v156
  v_cvt_pk_bf16_f32 v181, v154, v155
  v_exp_f32 v157, v157
  v_exp_f32 v158, v158
  v_cvt_pk_bf16_f32 v182, v156, v157
  v_exp_f32 v159, v159
  v_sub_f32 v160, v160, v4
  v_sub_f32 v161, v161, v4
  v_sub_f32 v162, v162, v4
  v_sub_f32 v163, v163, v4
  v_sub_f32 v164, v164, v4
  v_sub_f32 v165, v165, v4
  v_sub_f32 v166, v166, v4
  v_sub_f32 v167, v167, v4
  v_exp_f32 v160, v160
  v_cvt_pk_bf16_f32 v183, v158, v159
  v_exp_f32 v161, v161
  v_exp_f32 v162, v162
  v_mfma_f32_32x32x16_bf16 v[224:239], v[116:119], v[180:183], v[224:239]
  v_cvt_pk_bf16_f32 v184, v160, v161
  v_exp_f32 v163, v163
  v_exp_f32 v164, v164
  v_cvt_pk_bf16_f32 v185, v162, v163
  v_exp_f32 v165, v165
  v_exp_f32 v166, v166
  v_cvt_pk_bf16_f32 v186, v164, v165
  v_exp_f32 v167, v167
  v_sub_f32 v168, v168, v4
  v_sub_f32 v169, v169, v4
  v_sub_f32 v170, v170, v4
  v_sub_f32 v171, v171, v4
  v_sub_f32 v172, v172, v4
  v_sub_f32 v173, v173, v4
  v_sub_f32 v174, v174, v4
  v_sub_f32 v175, v175, v4
  v_exp_f32 v168, v168
  v_cvt_pk_bf16_f32 v187, v166, v167
  v_exp_f32 v169, v169
  v_exp_f32 v170, v170
  v_mfma_f32_32x32x16_bf16 v[240:255], v[112:115], v[184:187], v[240:255]
  v_cvt_pk_bf16_f32 v188, v168, v169
  v_exp_f32 v171, v171
  v_exp_f32 v172, v172
  v_cvt_pk_bf16_f32 v189, v170, v171
  v_exp_f32 v173, v173
  v_exp_f32 v174, v174
  v_cvt_pk_bf16_f32 v190, v172, v173
  v_exp_f32 v175, v175
  s_nop 0
  v_cvt_pk_bf16_f32 v191, v174, v175
  s_nop 1
  v_mfma_f32_32x32x16_bf16 v[240:255], v[116:119], v[188:191], v[240:255]
  s_cmp_lt_u32 s61, 3
  s_cbranch_scc1 L_p2end_100002
  v_mfma_f32_32x32x16_bf16 v[144:159], v[60:63], v[16:19], 0
  s_nop 11
  v_sub_f32 v144, v144, v3
  v_sub_f32 v145, v145, v3
  v_sub_f32 v146, v146, v3
  v_sub_f32 v147, v147, v3
  v_sub_f32 v148, v148, v3
  v_sub_f32 v149, v149, v3
  v_sub_f32 v150, v150, v3
  v_sub_f32 v151, v151, v3
  v_exp_f32 v144, v144
  v_exp_f32 v145, v145
  v_exp_f32 v146, v146
  v_cvt_pk_bf16_f32 v176, v144, v145
  v_exp_f32 v147, v147
  v_exp_f32 v148, v148
  v_cvt_pk_bf16_f32 v177, v146, v147
  v_exp_f32 v149, v149
  v_mfma_f32_32x32x16_bf16 v[160:175], v[60:63], v[20:23], 0
  v_exp_f32 v150, v150
  v_cvt_pk_bf16_f32 v178, v148, v149
  v_exp_f32 v151, v151
  v_sub_f32 v152, v152, v3
  v_sub_f32 v153, v153, v3
  v_sub_f32 v154, v154, v3
  v_sub_f32 v155, v155, v3
  v_sub_f32 v156, v156, v3
  v_sub_f32 v157, v157, v3
  v_sub_f32 v158, v158, v3
  v_sub_f32 v159, v159, v3
  v_exp_f32 v152, v152
  v_cvt_pk_bf16_f32 v179, v150, v151
  v_exp_f32 v153, v153
  v_exp_f32 v154, v154
  v_mfma_f32_32x32x16_bf16 v[224:239], v[104:107], v[176:179], v[224:239]
  v_cvt_pk_bf16_f32 v180, v152, v153
  v_exp_f32 v155, v155
  v_exp_f32 v156, v156
  v_cvt_pk_bf16_f32 v181, v154, v155
  v_exp_f32 v157, v157
  v_exp_f32 v158, v158
  v_cvt_pk_bf16_f32 v182, v156, v157
  v_exp_f32 v159, v159
  v_sub_f32 v160, v160, v4
  v_sub_f32 v161, v161, v4
  v_sub_f32 v162, v162, v4
  v_sub_f32 v163, v163, v4
  v_sub_f32 v164, v164, v4
  v_sub_f32 v165, v165, v4
  v_sub_f32 v166, v166, v4
  v_sub_f32 v167, v167, v4
  v_exp_f32 v160, v160
  v_cvt_pk_bf16_f32 v183, v158, v159
  v_exp_f32 v161, v161
  v_exp_f32 v162, v162
  v_mfma_f32_32x32x16_bf16 v[224:239], v[108:111], v[180:183], v[224:239]
  v_cvt_pk_bf16_f32 v184, v160, v161
  v_exp_f32 v163, v163
  v_exp_f32 v164, v164
  v_cvt_pk_bf16_f32 v185, v162, v163
  v_exp_f32 v165, v165
  v_mfma_f32_32x32x16_bf16 v[144:159], v[56:59], v[16:19], 0
  v_exp_f32 v166, v166
  v_cvt_pk_bf16_f32 v186, v164, v165
  v_exp_f32 v167, v167
  v_sub_f32 v168, v168, v4
  v_sub_f32 v169, v169, v4
  v_sub_f32 v170, v170, v4
  v_sub_f32 v171, v171, v4
  v_sub_f32 v172, v172, v4
  v_sub_f32 v173, v173, v4
  v_sub_f32 v174, v174, v4
  v_sub_f32 v175, v175, v4
  v_exp_f32 v168, v168
  v_cvt_pk_bf16_f32 v187, v166, v167
  v_exp_f32 v169, v169
  v_exp_f32 v170, v170
  v_mfma_f32_32x32x16_bf16 v[240:255], v[104:107], v[184:187], v[240:255]
  v_cvt_pk_bf16_f32 v188, v168, v169
  v_exp_f32 v171, v171
  v_exp_f32 v172, v172
  v_cvt_pk_bf16_f32 v189, v170, v171
  v_exp_f32 v173, v173
  v_exp_f32 v174, v174
  v_cvt_pk_bf16_f32 v190, v172, v173
  v_exp_f32 v175, v175
  v_sub_f32 v144, v144, v3
  v_sub_f32 v145, v145, v3
  v_sub_f32 v146, v146, v3
  v_sub_f32 v147, v147, v3
  v_sub_f32 v148, v148, v3
  v_sub_f32 v149, v149, v3
  v_sub_f32 v150, v150, v3
  v_sub_f32 v151, v151, v3
  v_exp_f32 v144, v144
  v_cvt_pk_bf16_f32 v191, v174, v175
  v_exp_f32 v145, v145
  v_exp_f32 v146, v146
  v_mfma_f32_32x32x16_bf16 v[240:255], v[108:111], v[188:191], v[240:255]
  v_cvt_pk_bf16_f32 v176, v144, v145
  v_exp_f32 v147, v147
  v_exp_f32 v148, v148
  v_cvt_pk_bf16_f32 v177, v146, v147
  v_exp_f32 v149, v149
  v_mfma_f32_32x32x16_bf16 v[160:175], v[56:59], v[20:23], 0
  v_exp_f32 v150, v150
  v_cvt_pk_bf16_f32 v178, v148, v149
  v_exp_f32 v151, v151
  v_sub_f32 v152, v152, v3
  v_sub_f32 v153, v153, v3
  v_sub_f32 v154, v154, v3
  v_sub_f32 v155, v155, v3
  v_sub_f32 v156, v156, v3
  v_sub_f32 v157, v157, v3
  v_sub_f32 v158, v158, v3
  v_sub_f32 v159, v159, v3
  v_exp_f32 v152, v152
  v_cvt_pk_bf16_f32 v179, v150, v151
  v_exp_f32 v153, v153
  v_exp_f32 v154, v154
  v_mfma_f32_32x32x16_bf16 v[224:239], v[96:99], v[176:179], v[224:239]
  v_cvt_pk_bf16_f32 v180, v152, v153
  v_exp_f32 v155, v155
  v_exp_f32 v156, v156
  v_cvt_pk_bf16_f32 v181, v154, v155
  v_exp_f32 v157, v157
  v_exp_f32 v158, v158
  v_cvt_pk_bf16_f32 v182, v156, v157
  v_exp_f32 v159, v159
  v_sub_f32 v160, v160, v4
  v_sub_f32 v161, v161, v4
  v_sub_f32 v162, v162, v4
  v_sub_f32 v163, v163, v4
  v_sub_f32 v164, v164, v4
  v_sub_f32 v165, v165, v4
  v_sub_f32 v166, v166, v4
  v_sub_f32 v167, v167, v4
  v_exp_f32 v160, v160
  v_cvt_pk_bf16_f32 v183, v158, v159
  v_exp_f32 v161, v161
  v_exp_f32 v162, v162
  v_mfma_f32_32x32x16_bf16 v[224:239], v[100:103], v[180:183], v[224:239]
  v_cvt_pk_bf16_f32 v184, v160, v161
  v_exp_f32 v163, v163
  v_exp_f32 v164, v164
  v_cvt_pk_bf16_f32 v185, v162, v163
  v_exp_f32 v165, v165
  v_exp_f32 v166, v166
  v_cvt_pk_bf16_f32 v186, v164, v165
  v_exp_f32 v167, v167
  v_sub_f32 v168, v168, v4
  v_sub_f32 v169, v169, v4
  v_sub_f32 v170, v170, v4
  v_sub_f32 v171, v171, v4
  v_sub_f32 v172, v172, v4
  v_sub_f32 v173, v173, v4
  v_sub_f32 v174, v174, v4
  v_sub_f32 v175, v175, v4
  v_exp_f32 v168, v168
  v_cvt_pk_bf16_f32 v187, v166, v167
  v_exp_f32 v169, v169
  v_exp_f32 v170, v170
  v_mfma_f32_32x32x16_bf16 v[240:255], v[96:99], v[184:187], v[240:255]
  v_cvt_pk_bf16_f32 v188, v168, v169
  v_exp_f32 v171, v171
  v_exp_f32 v172, v172
  v_cvt_pk_bf16_f32 v189, v170, v171
  v_exp_f32 v173, v173
  v_exp_f32 v174, v174
  v_cvt_pk_bf16_f32 v190, v172, v173
  v_exp_f32 v175, v175
  s_nop 0
  v_cvt_pk_bf16_f32 v191, v174, v175
  s_nop 1
  v_mfma_f32_32x32x16_bf16 v[240:255], v[100:103], v[188:191], v[240:255]
  s_cmp_lt_u32 s61, 4
  s_cbranch_scc1 L_p2end_100002
  v_mfma_f32_32x32x16_bf16 v[144:159], v[52:55], v[16:19], 0
  s_nop 11
  v_sub_f32 v144, v144, v3
  v_sub_f32 v145, v145, v3
  v_sub_f32 v146, v146, v3
  v_sub_f32 v147, v147, v3
  v_sub_f32 v148, v148, v3
  v_sub_f32 v149, v149, v3
  v_sub_f32 v150, v150, v3
  v_sub_f32 v151, v151, v3
  v_exp_f32 v144, v144
  v_exp_f32 v145, v145
  v_exp_f32 v146, v146
  v_cvt_pk_bf16_f32 v176, v144, v145
  v_exp_f32 v147, v147
  v_exp_f32 v148, v148
  v_cvt_pk_bf16_f32 v177, v146, v147
  v_exp_f32 v149, v149
  v_mfma_f32_32x32x16_bf16 v[160:175], v[52:55], v[20:23], v[208:223]
  v_exp_f32 v150, v150
  v_cvt_pk_bf16_f32 v178, v148, v149
  v_exp_f32 v151, v151
  v_sub_f32 v152, v152, v3
  v_sub_f32 v153, v153, v3
  v_sub_f32 v154, v154, v3
  v_sub_f32 v155, v155, v3
  v_sub_f32 v156, v156, v3
  v_sub_f32 v157, v157, v3
  v_sub_f32 v158, v158, v3
  v_sub_f32 v159, v159, v3
  v_exp_f32 v152, v152
  v_cvt_pk_bf16_f32 v179, v150, v151
  v_exp_f32 v153, v153
  v_exp_f32 v154, v154
  v_mfma_f32_32x32x16_bf16 v[224:239], v[88:91], v[176:179], v[224:239]
  v_cvt_pk_bf16_f32 v180, v152, v153
  v_exp_f32 v155, v155
  v_exp_f32 v156, v156
  v_cvt_pk_bf16_f32 v181, v154, v155
  v_exp_f32 v157, v157
  v_exp_f32 v158, v158
  v_cvt_pk_bf16_f32 v182, v156, v157
  v_exp_f32 v159, v159
  v_sub_f32 v160, v160, v4
  v_sub_f32 v161, v161, v4
  v_sub_f32 v162, v162, v4
  v_sub_f32 v163, v163, v4
  v_sub_f32 v164, v164, v4
  v_sub_f32 v165, v165, v4
  v_sub_f32 v166, v166, v4
  v_sub_f32 v167, v167, v4
  v_exp_f32 v160, v160
  v_cvt_pk_bf16_f32 v183, v158, v159
  v_exp_f32 v161, v161
  v_exp_f32 v162, v162
  v_mfma_f32_32x32x16_bf16 v[224:239], v[92:95], v[180:183], v[224:239]
  v_cvt_pk_bf16_f32 v184, v160, v161
  v_exp_f32 v163, v163
  v_exp_f32 v164, v164
  v_cvt_pk_bf16_f32 v185, v162, v163
  v_exp_f32 v165, v165
  v_mfma_f32_32x32x16_bf16 v[144:159], v[48:51], v[16:19], v[208:223]
  v_exp_f32 v166, v166
  v_cvt_pk_bf16_f32 v186, v164, v165
  v_exp_f32 v167, v167
  v_sub_f32 v168, v168, v4
  v_sub_f32 v169, v169, v4
  v_sub_f32 v170, v170, v4
  v_sub_f32 v171, v171, v4
  v_sub_f32 v172, v172, v4
  v_sub_f32 v173, v173, v4
  v_sub_f32 v174, v174, v4
  v_sub_f32 v175, v175, v4
  v_exp_f32 v168, v168
  v_cvt_pk_bf16_f32 v187, v166, v167
  v_exp_f32 v169, v169
  v_exp_f32 v170, v170
  v_mfma_f32_32x32x16_bf16 v[240:255], v[88:91], v[184:187], v[240:255]
  v_cvt_pk_bf16_f32 v188, v168, v169
  v_exp_f32 v171, v171
  v_exp_f32 v172, v172
  v_cvt_pk_bf16_f32 v189, v170, v171
  v_exp_f32 v173, v173
  v_exp_f32 v174, v174
  v_cvt_pk_bf16_f32 v190, v172, v173
  v_exp_f32 v175, v175
  v_sub_f32 v144, v144, v3
  v_sub_f32 v145, v145, v3
  v_sub_f32 v146, v146, v3
  v_sub_f32 v147, v147, v3
  v_sub_f32 v148, v148, v3
  v_sub_f32 v149, v149, v3
  v_sub_f32 v150, v150, v3
  v_sub_f32 v151, v151, v3
  v_exp_f32 v144, v144
  v_cvt_pk_bf16_f32 v191, v174, v175
  v_exp_f32 v145, v145
  v_exp_f32 v146, v146
  v_mfma_f32_32x32x16_bf16 v[240:255], v[92:95], v[188:191], v[240:255]
  v_cvt_pk_bf16_f32 v176, v144, v145
  v_exp_f32 v147, v147
  v_exp_f32 v148, v148
  v_cvt_pk_bf16_f32 v177, v146, v147
  v_exp_f32 v149, v149
  v_exp_f32 v150, v150
  v_cvt_pk_bf16_f32 v178, v148, v149
  v_exp_f32 v151, v151
  v_sub_f32 v152, v152, v3
  v_sub_f32 v153, v153, v3
  v_sub_f32 v154, v154, v3
  v_sub_f32 v155, v155, v3
  v_sub_f32 v156, v156, v3
  v_sub_f32 v157, v157, v3
  v_sub_f32 v158, v158, v3
  v_sub_f32 v159, v159, v3
  v_exp_f32 v152, v152
  v_cvt_pk_bf16_f32 v179, v150, v151
  v_exp_f32 v153, v153
  v_exp_f32 v154, v154
  v_mfma_f32_32x32x16_bf16 v[224:239], v[80:83], v[176:179], v[224:239]
  v_cvt_pk_bf16_f32 v180, v152, v153
  v_exp_f32 v155, v155
  v_exp_f32 v156, v156
  v_cvt_pk_bf16_f32 v181, v154, v155
  v_exp_f32 v157, v157
  v_exp_f32 v158, v158
  v_cvt_pk_bf16_f32 v182, v156, v157
  v_exp_f32 v159, v159
  s_nop 0
  v_cvt_pk_bf16_f32 v183, v158, v159
  s_nop 1
  v_mfma_f32_32x32x16_bf16 v[224:239], v[84:87], v[180:183], v[224:239]
  s_nop 7
L_p2end_100002:
  s_nop 7
  v_lshlrev_b32 v15, 4, v0
  s_mov_b32 s1, 268288
  buffer_load_dwordx4 v[112:115], v15, s[52:55], s1 offen sc1
  s_mov_b32 s1, 280576
  buffer_load_dwordx4 v[116:119], v15, s[52:55], s1 offen sc1
  s_mov_b32 s1, 292864
  buffer_load_dwordx4 v[120:123], v15, s[52:55], s1 offen sc1
  s_mov_b32 s1, 305152
  buffer_load_dwordx4 v[124:127], v15, s[52:55], s1 offen sc1
  s_mov_b32 s1, 266240
  buffer_load_dwordx4 v[128:131], v11, s[52:55], s1 offen sc1
  s_mov_b32 s1, 278528
  buffer_load_dwordx4 v[132:135], v11, s[52:55], s1 offen sc1
  s_mov_b32 s1, 290816
  buffer_load_dwordx4 v[136:139], v11, s[52:55], s1 offen sc1
  s_mov_b32 s1, 303104
  buffer_load_dwordx4 v[140:143], v11, s[52:55], s1 offen sc1
  s_waitcnt vmcnt(0)
  s_branch L_attfin_19
L_slow_23:
  buffer_store_dword v3, off, s[52:55], s15 offset:0 sc1
  s_nop 1
  s_branch L_back_24
L_slow_28:
  buffer_store_dword v3, off, s[52:55], s26 offset:0 sc1
  s_nop 1
  s_branch L_back_29
L_slow_33:
  buffer_store_dword v3, off, s[52:55], s72 offset:0 sc1
  s_nop 1
  s_branch L_back_34
L_slow_38:
  buffer_store_dword v3, off, s[52:55], s72 offset:128 sc1
  s_nop 1
  s_branch L_back_39
L_slow_40:
  buffer_store_dword v3, off, s[52:55], s72 offset:256 sc1
  s_nop 1
  s_branch L_back_41
  s_endpgm
.fill 2048, 4, 0xbf800000
  s_endpgm
.section .rodata,"a"
.p2align 6
.amdhsa_kernel adaLN_cond__sliding_block__dense_activation_relu__prompt_kernel
  .amdhsa_next_free_vgpr 512
  .amdhsa_next_free_sgpr 102
  .amdhsa_accum_offset 256
  .amdhsa_group_segment_fixed_size 0
  .amdhsa_kernarg_size 88
  .amdhsa_user_sgpr_count 2
  .amdhsa_user_sgpr_kernarg_segment_ptr 1
  .amdhsa_system_sgpr_workgroup_id_x 1
  .amdhsa_float_denorm_mode_32 3
.end_amdhsa_kernel
```
